```python
import torch

def _softmax(x, axis=-1):
    return torch.softmax(x, dim=axis)
def _gelu(x):
    return torch.nn.functional.gelu(x, approximate="tanh")
def _silu(x):
    return torch.nn.functional.silu(x)
def _sigmoid(x):
    return torch.sigmoid(x)
def _layernorm(x, axis=-1, eps=1e-5):
    m = x.mean(dim=axis, keepdim=True)
    v = x.var(dim=axis, keepdim=True, unbiased=False)
    return (x - m) / torch.sqrt(v + eps)
def _scatter_add(tgt, idx, src, axis=0):
    return tgt.clone().index_add_(axis, idx, src)
def _segment_sum(src, seg, n):
    out = torch.zeros((n,) + src.shape[1:], dtype=src.dtype)
    return out.index_add_(0, seg, src)
def _pad(x, pw):
    flat = tuple(v for pair in reversed(pw) for v in pair)
    return torch.nn.functional.pad(x, flat)

kernel_name = 'standalone__standard_2d_1d_3d_conv__vision'

def setup_inputs():

    _w = (lambda a: (lambda t: t.to(torch.bfloat16) if t.is_floating_point() else t)(torch.as_tensor(a)))
    H = W = 384
    C = 192
    K = 1
    return {
        "x": _w((lambda *s: torch.randn(*s, dtype=torch.bfloat16) * 0.05)(1, H, W, C)),
        "w": _w((lambda *s: torch.randn(*s, dtype=torch.bfloat16) * 0.05)(K, K, C, C)),
        "b": _w((lambda *s: torch.randn(*s, dtype=torch.bfloat16) * 0.05)(C)),
    }

def reference(x, w, b):
    B, H, W, Cin = x.shape
    K = w.shape[0]
    pl = (K - 1) // 2
    pr = K // 2
    xp = _pad(x, ((0, 0), (pl, pr), (pl, pr), (0, 0)))
    out = sum(
        torch.einsum('bhwc,cd->bhwd', xp[:, i:i+H, j:j+W, :], w[i, j])
        for i in range(K) for j in range(K)
    )
    return out + b[None, None, None, :]
```

```asm
; @launch grid=(256,1,1) block=(512,1,1) lds=148480
.amdgcn_target "amdgcn-amd-amdhsa--gfx950"
.text
.globl standalone__standard_2d_1d_3d_conv__vision_kernel
.p2align 8
.type standalone__standard_2d_1d_3d_conv__vision_kernel,@function
standalone__standard_2d_1d_3d_conv__vision_kernel:
    s_cmp_ge_u32 s2, 256
    s_cbranch_scc1 L_end
    s_load_dwordx4 s[4:7], s[0:1], 0
    s_load_dwordx4 s[24:27], s[0:1], 16
    v_lshrrev_b32 v1, 6, v0
    v_and_b32 v2, 63, v0
    v_readfirstlane_b32 s3, v1
    s_mov_b32 s10, 56623104
    s_mov_b32 s11, 0x00020000
    s_mov_b32 s14, 73728
    s_mov_b32 s15, 0x00020000
    s_cmp_lt_u32 s3, 4
    s_cbranch_scc1 L_compute
    s_setprio 2
    v_add_u32 v3, 0, v2
    v_mul_u32_u24 v3, 2731, v3
    v_bfe_u32 v4, v3, 16, 2
    v_xor_b32 v3, v4, v2
    v_lshlrev_b32 v8, 4, v3
    v_xor_b32 v11, 64, v8
    v_add_u32 v3, 64, v2
    v_mul_u32_u24 v3, 2731, v3
    v_bfe_u32 v4, v3, 16, 2
    v_xor_b32 v3, v4, v2
    v_lshlrev_b32 v9, 4, v3
    v_xor_b32 v12, 64, v9
    v_add_u32 v3, 128, v2
    v_mul_u32_u24 v3, 2731, v3
    v_bfe_u32 v4, v3, 16, 2
    v_xor_b32 v3, v4, v2
    v_lshlrev_b32 v10, 4, v3
    v_xor_b32 v13, 64, v10
    s_sub_u32 s3, s3, 4
    s_mul_i32 s29, s3, 6144
    s_mul_i32 s28, s2, 24576
    s_add_u32 s28, s28, s29
    s_mul_i32 s30, s3, 3
    s_lshr_b32 s35, s2, 3
    s_mul_i32 s37, s35, 43
    s_lshr_b32 s37, s37, 9
    s_mul_i32 s37, s37, 12
    s_sub_u32 s37, s35, s37
    s_add_u32 s30, s30, s37
    s_add_u32 s37, s30, 0
    s_sub_u32 s38, s37, 12
    s_cmp_ge_u32 s37, 12
    s_cselect_b32 s37, s38, s37
    s_mul_i32 s44, s37, 6144
    s_add_u32 s37, s30, 1
    s_sub_u32 s38, s37, 12
    s_cmp_ge_u32 s37, 12
    s_cselect_b32 s37, s38, s37
    s_mul_i32 s45, s37, 6144
    s_add_u32 s37, s30, 2
    s_sub_u32 s38, s37, 12
    s_cmp_ge_u32 s37, 12
    s_cselect_b32 s37, s38, s37
    s_mul_i32 s46, s37, 6144
    s_mov_b32 s18, 384
    s_mov_b32 s19, 0x00020000
    s_mov_b32 s22, 56623104
    s_mov_b32 s23, 0x00020000
    v_lshlrev_b32 v7, 4, v2
    v_lshl_add_u32 v15, v2, 4, s29
    v_add_u32 v14, 49152, v15
    s_bfe_u32 s35, s2, 0x20005
    s_waitcnt lgkmcnt(0)
    s_mov_b32 s8, s4
    s_mov_b32 s9, s5
    s_mov_b32 s12, s6
    s_mov_b32 s13, s7
    s_mov_b32 s16, s24
    s_mov_b32 s17, s25
    s_mov_b32 s20, s26
    s_mov_b32 s21, s27
    s_cmp_eq_u32 s35, 1
    s_cbranch_scc1 L_hg1
    s_cmp_eq_u32 s35, 2
    s_cbranch_scc1 L_hg2
    s_cmp_eq_u32 s35, 3
    s_cbranch_scc1 L_hg3
    s_mov_b32 m0, 147456
    s_nop 0
    buffer_load_dwordx4 v7, s[16:19], 0 offen lds
    s_add_u32 m0, s44, 73728
    s_add_u32 s31, s44, 0
    buffer_load_dwordx4 v8, s[12:15], s31 offen offset:0 lds
    buffer_load_dwordx4 v9, s[12:15], s31 offen offset:1024 lds
    buffer_load_dwordx4 v10, s[12:15], s31 offen offset:2048 lds
    buffer_load_dwordx4 v11, s[12:15], s31 offen offset:3072 lds
    s_add_u32 m0, s44, 77824
    s_add_u32 s31, s44, 4096
    buffer_load_dwordx4 v12, s[12:15], s31 offen offset:0 lds
    buffer_load_dwordx4 v13, s[12:15], s31 offen offset:1024 lds
    s_add_u32 m0, s45, 73728
    s_add_u32 s31, s45, 0
    buffer_load_dwordx4 v8, s[12:15], s31 offen offset:0 lds
    buffer_load_dwordx4 v9, s[12:15], s31 offen offset:1024 lds
    buffer_load_dwordx4 v10, s[12:15], s31 offen offset:2048 lds
    buffer_load_dwordx4 v11, s[12:15], s31 offen offset:3072 lds
    s_add_u32 m0, s45, 77824
    s_add_u32 s31, s45, 4096
    buffer_load_dwordx4 v12, s[12:15], s31 offen offset:0 lds
    buffer_load_dwordx4 v13, s[12:15], s31 offen offset:1024 lds
    s_add_u32 m0, s46, 73728
    s_add_u32 s31, s46, 0
    buffer_load_dwordx4 v8, s[12:15], s31 offen offset:0 lds
    buffer_load_dwordx4 v9, s[12:15], s31 offen offset:1024 lds
    buffer_load_dwordx4 v10, s[12:15], s31 offen offset:2048 lds
    buffer_load_dwordx4 v11, s[12:15], s31 offen offset:3072 lds
    s_add_u32 m0, s46, 77824
    s_add_u32 s31, s46, 4096
    buffer_load_dwordx4 v12, s[12:15], s31 offen offset:0 lds
    buffer_load_dwordx4 v13, s[12:15], s31 offen offset:1024 lds
    s_add_u32 s33, s28, 0
    s_add_u32 s34, s28, 4096
    buffer_load_dwordx4 v[16:19], v8, s[8:11], s33 offen offset:0 nt
    buffer_load_dwordx4 v[20:23], v9, s[8:11], s33 offen offset:1024 nt
    buffer_load_dwordx4 v[24:27], v10, s[8:11], s33 offen offset:2048 nt
    buffer_load_dwordx4 v[28:31], v11, s[8:11], s33 offen offset:3072 nt
    buffer_load_dwordx4 v[32:35], v12, s[8:11], s34 offen offset:0 nt
    buffer_load_dwordx4 v[36:39], v13, s[8:11], s34 offen offset:1024 nt
    s_add_u32 s33, s28, 6291456
    s_add_u32 s34, s28, 6295552
    buffer_load_dwordx4 v[40:43], v8, s[8:11], s33 offen offset:0 nt
    buffer_load_dwordx4 v[44:47], v9, s[8:11], s33 offen offset:1024 nt
    buffer_load_dwordx4 v[48:51], v10, s[8:11], s33 offen offset:2048 nt
    buffer_load_dwordx4 v[52:55], v11, s[8:11], s33 offen offset:3072 nt
    buffer_load_dwordx4 v[56:59], v12, s[8:11], s34 offen offset:0 nt
    buffer_load_dwordx4 v[60:63], v13, s[8:11], s34 offen offset:1024 nt
    s_add_u32 s33, s28, 12582912
    s_add_u32 s34, s28, 12587008
    buffer_load_dwordx4 v[64:67], v8, s[8:11], s33 offen offset:0 nt
    buffer_load_dwordx4 v[68:71], v9, s[8:11], s33 offen offset:1024 nt
    s_waitcnt vmcnt(8)
    ds_write_b128 v15, v[16:19] offset:0
    ds_write_b128 v15, v[20:23] offset:1024
    ds_write_b128 v15, v[24:27] offset:2048
    ds_write_b128 v15, v[28:31] offset:3072
    ds_write_b128 v15, v[32:35] offset:4096
    ds_write_b128 v15, v[36:39] offset:5120
    s_waitcnt lgkmcnt(0)
    s_barrier
    s_waitcnt vmcnt(3)
    buffer_load_dwordx4 v[72:75], v10, s[8:11], s33 offen offset:2048 nt
    s_waitcnt vmcnt(3)
    buffer_load_dwordx4 v[76:79], v11, s[8:11], s33 offen offset:3072 nt
    ds_write_b128 v15, v[40:43] offset:24576
    s_waitcnt vmcnt(3)
    buffer_load_dwordx4 v[80:83], v12, s[8:11], s34 offen offset:0 nt
    ds_write_b128 v15, v[44:47] offset:25600
    s_waitcnt vmcnt(3)
    buffer_load_dwordx4 v[84:87], v13, s[8:11], s34 offen offset:1024 nt
    ds_write_b128 v15, v[48:51] offset:26624
    s_waitcnt vmcnt(3)
    s_add_u32 s33, s28, 18874368
    s_add_u32 s34, s28, 18878464
    buffer_load_dwordx4 v[88:91], v8, s[8:11], s33 offen offset:0 nt
    ds_write_b128 v15, v[52:55] offset:27648
    s_waitcnt vmcnt(3)
    buffer_load_dwordx4 v[92:95], v9, s[8:11], s33 offen offset:1024 nt
    ds_write_b128 v15, v[56:59] offset:28672
    s_waitcnt vmcnt(3)
    buffer_load_dwordx4 v[96:99], v10, s[8:11], s33 offen offset:2048 nt
    ds_write_b128 v15, v[60:63] offset:29696
    s_waitcnt vmcnt(3)
    buffer_load_dwordx4 v[100:103], v11, s[8:11], s33 offen offset:3072 nt
    s_waitcnt lgkmcnt(0)
    s_barrier
    buffer_load_dwordx4 v[104:107], v12, s[8:11], s34 offen offset:0 nt
    ds_read_b128 v[16:19], v14 offset:0
    ds_read_b128 v[20:23], v14 offset:1024
    ds_read_b128 v[24:27], v14 offset:2048
    ds_read_b128 v[28:31], v14 offset:3072
    ds_read_b128 v[32:35], v14 offset:4096
    ds_read_b128 v[36:39], v14 offset:5120
    buffer_load_dwordx4 v[108:111], v13, s[8:11], s34 offen offset:1024 nt
    ds_write_b128 v15, v[64:67] offset:0
    s_add_u32 s33, s28, 25165824
    s_add_u32 s34, s28, 25169920
    buffer_load_dwordx4 v[112:115], v8, s[8:11], s33 offen offset:0 nt
    ds_write_b128 v15, v[68:71] offset:1024
    buffer_load_dwordx4 v[116:119], v9, s[8:11], s33 offen offset:1024 nt
    ds_write_b128 v15, v[72:75] offset:2048
    buffer_load_dwordx4 v[120:123], v10, s[8:11], s33 offen offset:2048 nt
    ds_write_b128 v15, v[76:79] offset:3072
    buffer_load_dwordx4 v[124:127], v11, s[8:11], s33 offen offset:3072 nt
    ds_write_b128 v15, v[80:83] offset:4096
    buffer_load_dwordx4 v[128:131], v12, s[8:11], s34 offen offset:0 nt
    ds_write_b128 v15, v[84:87] offset:5120
    buffer_load_dwordx4 v[132:135], v13, s[8:11], s34 offen offset:1024 nt
    s_waitcnt lgkmcnt(0)
    s_barrier
    s_add_u32 s33, s28, 31457280
    s_add_u32 s34, s28, 31461376
    buffer_load_dwordx4 v[136:139], v8, s[8:11], s33 offen offset:0 nt
    ds_read_b128 v[40:43], v14 offset:24576
    ds_read_b128 v[44:47], v14 offset:25600
    ds_read_b128 v[48:51], v14 offset:26624
    ds_read_b128 v[52:55], v14 offset:27648
    ds_read_b128 v[56:59], v14 offset:28672
    ds_read_b128 v[60:63], v14 offset:29696
    buffer_load_dwordx4 v[140:143], v9, s[8:11], s33 offen offset:1024 nt
    s_waitcnt vmcnt(13)
    ds_write_b128 v15, v[88:91] offset:24576
    buffer_load_dwordx4 v[144:147], v10, s[8:11], s33 offen offset:2048 nt
    s_waitcnt vmcnt(13)
    ds_write_b128 v15, v[92:95] offset:25600
    buffer_load_dwordx4 v[148:151], v11, s[8:11], s33 offen offset:3072 nt
    s_waitcnt vmcnt(13)
    ds_write_b128 v15, v[96:99] offset:26624
    buffer_load_dwordx4 v[152:155], v12, s[8:11], s34 offen offset:0 nt
    s_waitcnt vmcnt(13)
    ds_write_b128 v15, v[100:103] offset:27648
    buffer_load_dwordx4 v[156:159], v13, s[8:11], s34 offen offset:1024 nt
    s_waitcnt vmcnt(13)
    ds_write_b128 v15, v[104:107] offset:28672
    s_add_u32 s33, s28, 37748736
    s_add_u32 s34, s28, 37752832
    buffer_load_dwordx4 v[160:163], v8, s[8:11], s33 offen offset:0 nt
    s_waitcnt vmcnt(13)
    ds_write_b128 v15, v[108:111] offset:29696
    buffer_load_dwordx4 v[164:167], v9, s[8:11], s33 offen offset:1024 nt
    s_waitcnt lgkmcnt(0)
    s_barrier
    buffer_load_dwordx4 v[168:171], v10, s[8:11], s33 offen offset:2048 nt
    ds_read_b128 v[64:67], v14 offset:0
    ds_read_b128 v[68:71], v14 offset:1024
    ds_read_b128 v[72:75], v14 offset:2048
    ds_read_b128 v[76:79], v14 offset:3072
    ds_read_b128 v[80:83], v14 offset:4096
    ds_read_b128 v[84:87], v14 offset:5120
    buffer_load_dwordx4 v[172:175], v11, s[8:11], s33 offen offset:3072 nt
    s_waitcnt vmcnt(15)
    ds_write_b128 v15, v[112:115] offset:0
    buffer_load_dwordx4 v[176:179], v12, s[8:11], s34 offen offset:0 nt
    s_waitcnt vmcnt(15)
    ds_write_b128 v15, v[116:119] offset:1024
    buffer_load_dwordx4 v[180:183], v13, s[8:11], s34 offen offset:1024 nt
    s_waitcnt vmcnt(15)
    ds_write_b128 v15, v[120:123] offset:2048
    s_add_u32 s33, s28, 44040192
    s_add_u32 s34, s28, 44044288
    buffer_load_dwordx4 v[184:187], v8, s[8:11], s33 offen offset:0 nt
    s_waitcnt vmcnt(15)
    ds_write_b128 v15, v[124:127] offset:3072
    buffer_load_dwordx4 v[188:191], v9, s[8:11], s33 offen offset:1024 nt
    s_waitcnt vmcnt(15)
    ds_write_b128 v15, v[128:131] offset:4096
    buffer_load_dwordx4 v[192:195], v10, s[8:11], s33 offen offset:2048 nt
    s_waitcnt vmcnt(15)
    ds_write_b128 v15, v[132:135] offset:5120
    buffer_load_dwordx4 v[196:199], v11, s[8:11], s33 offen offset:3072 nt
    s_waitcnt lgkmcnt(0)
    s_barrier
    buffer_load_dwordx4 v[200:203], v12, s[8:11], s34 offen offset:0 nt
    ds_read_b128 v[88:91], v14 offset:24576
    ds_read_b128 v[92:95], v14 offset:25600
    ds_read_b128 v[96:99], v14 offset:26624
    ds_read_b128 v[100:103], v14 offset:27648
    ds_read_b128 v[104:107], v14 offset:28672
    ds_read_b128 v[108:111], v14 offset:29696
    buffer_load_dwordx4 v[204:207], v13, s[8:11], s34 offen offset:1024 nt
    s_waitcnt vmcnt(17)
    ds_write_b128 v15, v[136:139] offset:24576
    s_add_u32 s33, s28, 50331648
    s_add_u32 s34, s28, 50335744
    buffer_load_dwordx4 v[208:211], v8, s[8:11], s33 offen offset:0 nt
    s_waitcnt vmcnt(17)
    ds_write_b128 v15, v[140:143] offset:25600
    buffer_load_dwordx4 v[212:215], v9, s[8:11], s33 offen offset:1024 nt
    s_waitcnt vmcnt(17)
    ds_write_b128 v15, v[144:147] offset:26624
    buffer_load_dwordx4 v[216:219], v10, s[8:11], s33 offen offset:2048 nt
    s_waitcnt vmcnt(17)
    ds_write_b128 v15, v[148:151] offset:27648
    buffer_load_dwordx4 v[220:223], v11, s[8:11], s33 offen offset:3072 nt
    s_waitcnt vmcnt(17)
    ds_write_b128 v15, v[152:155] offset:28672
    buffer_load_dwordx4 v[224:227], v12, s[8:11], s34 offen offset:0 nt
    s_waitcnt vmcnt(17)
    ds_write_b128 v15, v[156:159] offset:29696
    buffer_load_dwordx4 v[228:231], v13, s[8:11], s34 offen offset:1024 nt
    s_waitcnt lgkmcnt(0)
    s_barrier
    s_add_u32 s33, s28, 0
    s_add_u32 s34, s28, 4096
    buffer_store_dwordx4 v[16:19], v8, s[20:23], s33 offen offset:0 sc1
    ds_read_b128 v[112:115], v14 offset:0
    ds_read_b128 v[116:119], v14 offset:1024
    ds_read_b128 v[120:123], v14 offset:2048
    ds_read_b128 v[124:127], v14 offset:3072
    ds_read_b128 v[128:131], v14 offset:4096
    ds_read_b128 v[132:135], v14 offset:5120
    buffer_store_dwordx4 v[20:23], v9, s[20:23], s33 offen offset:1024 sc1 nt
    s_waitcnt vmcnt(19)
    ds_write_b128 v15, v[160:163] offset:0
    buffer_store_dwordx4 v[24:27], v10, s[20:23], s33 offen offset:2048 sc1 nt
    s_waitcnt vmcnt(19)
    ds_write_b128 v15, v[164:167] offset:1024
    buffer_store_dwordx4 v[28:31], v11, s[20:23], s33 offen offset:3072 sc1
    s_waitcnt vmcnt(19)
    ds_write_b128 v15, v[168:171] offset:2048
    buffer_store_dwordx4 v[32:35], v12, s[20:23], s34 offen offset:0 sc1 nt
    s_waitcnt vmcnt(19)
    ds_write_b128 v15, v[172:175] offset:3072
    buffer_store_dwordx4 v[36:39], v13, s[20:23], s34 offen offset:1024 sc1 nt
    s_waitcnt vmcnt(19)
    ds_write_b128 v15, v[176:179] offset:4096
    s_add_u32 s33, s28, 6291456
    s_add_u32 s34, s28, 6295552
    buffer_store_dwordx4 v[40:43], v8, s[20:23], s33 offen offset:0 sc1
    s_waitcnt vmcnt(19)
    ds_write_b128 v15, v[180:183] offset:5120
    buffer_store_dwordx4 v[44:47], v9, s[20:23], s33 offen offset:1024 sc1 nt
    s_waitcnt lgkmcnt(0)
    s_barrier
    buffer_store_dwordx4 v[48:51], v10, s[20:23], s33 offen offset:2048 sc1 nt
    ds_read_b128 v[136:139], v14 offset:24576
    ds_read_b128 v[140:143], v14 offset:25600
    ds_read_b128 v[144:147], v14 offset:26624
    ds_read_b128 v[148:151], v14 offset:27648
    ds_read_b128 v[152:155], v14 offset:28672
    ds_read_b128 v[156:159], v14 offset:29696
    buffer_store_dwordx4 v[52:55], v11, s[20:23], s33 offen offset:3072 sc1
    s_waitcnt vmcnt(21)
    ds_write_b128 v15, v[184:187] offset:24576
    buffer_store_dwordx4 v[56:59], v12, s[20:23], s34 offen offset:0 sc1 nt
    s_waitcnt vmcnt(21)
    ds_write_b128 v15, v[188:191] offset:25600
    buffer_store_dwordx4 v[60:63], v13, s[20:23], s34 offen offset:1024 sc1 nt
    s_waitcnt vmcnt(21)
    ds_write_b128 v15, v[192:195] offset:26624
    s_add_u32 s33, s28, 12582912
    s_add_u32 s34, s28, 12587008
    buffer_store_dwordx4 v[64:67], v8, s[20:23], s33 offen offset:0 sc1
    s_waitcnt vmcnt(21)
    ds_write_b128 v15, v[196:199] offset:27648
    buffer_store_dwordx4 v[68:71], v9, s[20:23], s33 offen offset:1024 sc1 nt
    s_waitcnt vmcnt(21)
    ds_write_b128 v15, v[200:203] offset:28672
    buffer_store_dwordx4 v[72:75], v10, s[20:23], s33 offen offset:2048 sc1 nt
    s_waitcnt vmcnt(21)
    ds_write_b128 v15, v[204:207] offset:29696
    buffer_store_dwordx4 v[76:79], v11, s[20:23], s33 offen offset:3072 sc1
    buffer_store_dwordx4 v[80:83], v12, s[20:23], s34 offen offset:0 sc1 nt
    s_waitcnt lgkmcnt(0)
    s_barrier
    buffer_store_dwordx4 v[84:87], v13, s[20:23], s34 offen offset:1024 sc1 nt
    ds_read_b128 v[160:163], v14 offset:0
    ds_read_b128 v[164:167], v14 offset:1024
    ds_read_b128 v[168:171], v14 offset:2048
    ds_read_b128 v[172:175], v14 offset:3072
    ds_read_b128 v[176:179], v14 offset:4096
    ds_read_b128 v[180:183], v14 offset:5120
    s_add_u32 s33, s28, 18874368
    s_add_u32 s34, s28, 18878464
    buffer_store_dwordx4 v[88:91], v8, s[20:23], s33 offen offset:0 sc1
    s_waitcnt vmcnt(24)
    ds_write_b128 v15, v[208:211] offset:0
    buffer_store_dwordx4 v[92:95], v9, s[20:23], s33 offen offset:1024 sc1 nt
    s_waitcnt vmcnt(24)
    ds_write_b128 v15, v[212:215] offset:1024
    buffer_store_dwordx4 v[96:99], v10, s[20:23], s33 offen offset:2048 sc1 nt
    s_waitcnt vmcnt(24)
    ds_write_b128 v15, v[216:219] offset:2048
    buffer_store_dwordx4 v[100:103], v11, s[20:23], s33 offen offset:3072 sc1
    s_waitcnt vmcnt(24)
    ds_write_b128 v15, v[220:223] offset:3072
    buffer_store_dwordx4 v[104:107], v12, s[20:23], s34 offen offset:0 sc1 nt
    s_waitcnt vmcnt(24)
    ds_write_b128 v15, v[224:227] offset:4096
    buffer_store_dwordx4 v[108:111], v13, s[20:23], s34 offen offset:1024 sc1 nt
    s_waitcnt vmcnt(24)
    ds_write_b128 v15, v[228:231] offset:5120
    s_add_u32 s33, s28, 25165824
    s_add_u32 s34, s28, 25169920
    buffer_store_dwordx4 v[112:115], v8, s[20:23], s33 offen offset:0 sc1
    buffer_store_dwordx4 v[116:119], v9, s[20:23], s33 offen offset:1024 sc1 nt
    s_waitcnt lgkmcnt(0)
    s_barrier
    buffer_store_dwordx4 v[120:123], v10, s[20:23], s33 offen offset:2048 sc1 nt
    ds_read_b128 v[184:187], v14 offset:24576
    ds_read_b128 v[188:191], v14 offset:25600
    ds_read_b128 v[192:195], v14 offset:26624
    ds_read_b128 v[196:199], v14 offset:27648
    ds_read_b128 v[200:203], v14 offset:28672
    ds_read_b128 v[204:207], v14 offset:29696
    buffer_store_dwordx4 v[124:127], v11, s[20:23], s33 offen offset:3072 sc1
    buffer_store_dwordx4 v[128:131], v12, s[20:23], s34 offen offset:0 sc1 nt
    buffer_store_dwordx4 v[132:135], v13, s[20:23], s34 offen offset:1024 sc1 nt
    s_add_u32 s33, s28, 31457280
    s_add_u32 s34, s28, 31461376
    buffer_store_dwordx4 v[136:139], v8, s[20:23], s33 offen offset:0 sc1
    buffer_store_dwordx4 v[140:143], v9, s[20:23], s33 offen offset:1024 sc1 nt
    buffer_store_dwordx4 v[144:147], v10, s[20:23], s33 offen offset:2048 sc1 nt
    buffer_store_dwordx4 v[148:151], v11, s[20:23], s33 offen offset:3072 sc1
    buffer_store_dwordx4 v[152:155], v12, s[20:23], s34 offen offset:0 sc1 nt
    s_waitcnt lgkmcnt(0)
    s_barrier
    ds_read_b128 v[208:211], v14 offset:0
    ds_read_b128 v[212:215], v14 offset:1024
    ds_read_b128 v[216:219], v14 offset:2048
    ds_read_b128 v[220:223], v14 offset:3072
    ds_read_b128 v[224:227], v14 offset:4096
    ds_read_b128 v[228:231], v14 offset:5120
    buffer_store_dwordx4 v[156:159], v13, s[20:23], s34 offen offset:1024 sc1 nt
    s_add_u32 s33, s28, 37748736
    s_add_u32 s34, s28, 37752832
    buffer_store_dwordx4 v[160:163], v8, s[20:23], s33 offen offset:0 sc1
    buffer_store_dwordx4 v[164:167], v9, s[20:23], s33 offen offset:1024 sc1 nt
    buffer_store_dwordx4 v[168:171], v10, s[20:23], s33 offen offset:2048 sc1 nt
    buffer_store_dwordx4 v[172:175], v11, s[20:23], s33 offen offset:3072 sc1
    buffer_store_dwordx4 v[176:179], v12, s[20:23], s34 offen offset:0 sc1 nt
    buffer_store_dwordx4 v[180:183], v13, s[20:23], s34 offen offset:1024 sc1 nt
    s_add_u32 s33, s28, 44040192
    s_add_u32 s34, s28, 44044288
    buffer_store_dwordx4 v[184:187], v8, s[20:23], s33 offen offset:0 sc1
    buffer_store_dwordx4 v[188:191], v9, s[20:23], s33 offen offset:1024 sc1 nt
    buffer_store_dwordx4 v[192:195], v10, s[20:23], s33 offen offset:2048 sc1 nt
    buffer_store_dwordx4 v[196:199], v11, s[20:23], s33 offen offset:3072 sc1
    buffer_store_dwordx4 v[200:203], v12, s[20:23], s34 offen offset:0 sc1 nt
    buffer_store_dwordx4 v[204:207], v13, s[20:23], s34 offen offset:1024 sc1 nt
    s_add_u32 s33, s28, 50331648
    s_add_u32 s34, s28, 50335744
    s_waitcnt lgkmcnt(5)
    buffer_store_dwordx4 v[208:211], v8, s[20:23], s33 offen offset:0 sc1
    s_waitcnt lgkmcnt(4)
    buffer_store_dwordx4 v[212:215], v9, s[20:23], s33 offen offset:1024 sc1 nt
    s_waitcnt lgkmcnt(3)
    buffer_store_dwordx4 v[216:219], v10, s[20:23], s33 offen offset:2048 sc1 nt
    s_waitcnt lgkmcnt(2)
    buffer_store_dwordx4 v[220:223], v11, s[20:23], s33 offen offset:3072 sc1
    s_waitcnt lgkmcnt(1)
    buffer_store_dwordx4 v[224:227], v12, s[20:23], s34 offen offset:0 sc1 nt
    s_waitcnt lgkmcnt(0)
    buffer_store_dwordx4 v[228:231], v13, s[20:23], s34 offen offset:1024 sc1 nt
    s_endpgm
L_hg1:
    s_add_u32 s33, s28, 0
    s_add_u32 s34, s28, 4096
    buffer_load_dwordx4 v[16:19], v8, s[8:11], s33 offen offset:0 nt
    buffer_load_dwordx4 v[20:23], v9, s[8:11], s33 offen offset:1024 nt
    buffer_load_dwordx4 v[24:27], v10, s[8:11], s33 offen offset:2048 nt
    buffer_load_dwordx4 v[28:31], v11, s[8:11], s33 offen offset:3072 nt
    buffer_load_dwordx4 v[32:35], v12, s[8:11], s34 offen offset:0 nt
    buffer_load_dwordx4 v[36:39], v13, s[8:11], s34 offen offset:1024 nt
    s_mov_b32 m0, 147456
    s_nop 0
    buffer_load_dwordx4 v7, s[16:19], 0 offen lds
    s_add_u32 m0, s44, 73728
    s_add_u32 s31, s44, 0
    buffer_load_dwordx4 v8, s[12:15], s31 offen offset:0 lds
    buffer_load_dwordx4 v9, s[12:15], s31 offen offset:1024 lds
    buffer_load_dwordx4 v10, s[12:15], s31 offen offset:2048 lds
    buffer_load_dwordx4 v11, s[12:15], s31 offen offset:3072 lds
    s_add_u32 m0, s44, 77824
    s_add_u32 s31, s44, 4096
    buffer_load_dwordx4 v12, s[12:15], s31 offen offset:0 lds
    buffer_load_dwordx4 v13, s[12:15], s31 offen offset:1024 lds
    s_add_u32 m0, s45, 73728
    s_add_u32 s31, s45, 0
    buffer_load_dwordx4 v8, s[12:15], s31 offen offset:0 lds
    buffer_load_dwordx4 v9, s[12:15], s31 offen offset:1024 lds
    buffer_load_dwordx4 v10, s[12:15], s31 offen offset:2048 lds
    buffer_load_dwordx4 v11, s[12:15], s31 offen offset:3072 lds
    s_add_u32 m0, s45, 77824
    s_add_u32 s31, s45, 4096
    buffer_load_dwordx4 v12, s[12:15], s31 offen offset:0 lds
    buffer_load_dwordx4 v13, s[12:15], s31 offen offset:1024 lds
    s_add_u32 m0, s46, 73728
    s_add_u32 s31, s46, 0
    buffer_load_dwordx4 v8, s[12:15], s31 offen offset:0 lds
    buffer_load_dwordx4 v9, s[12:15], s31 offen offset:1024 lds
    buffer_load_dwordx4 v10, s[12:15], s31 offen offset:2048 lds
    buffer_load_dwordx4 v11, s[12:15], s31 offen offset:3072 lds
    s_add_u32 m0, s46, 77824
    s_add_u32 s31, s46, 4096
    buffer_load_dwordx4 v12, s[12:15], s31 offen offset:0 lds
    buffer_load_dwordx4 v13, s[12:15], s31 offen offset:1024 lds
    s_add_u32 s33, s28, 6291456
    s_add_u32 s34, s28, 6295552
    buffer_load_dwordx4 v[40:43], v8, s[8:11], s33 offen offset:0 nt
    buffer_load_dwordx4 v[44:47], v9, s[8:11], s33 offen offset:1024 nt
    buffer_load_dwordx4 v[48:51], v10, s[8:11], s33 offen offset:2048 nt
    buffer_load_dwordx4 v[52:55], v11, s[8:11], s33 offen offset:3072 nt
    buffer_load_dwordx4 v[56:59], v12, s[8:11], s34 offen offset:0 nt
    buffer_load_dwordx4 v[60:63], v13, s[8:11], s34 offen offset:1024 nt
    s_add_u32 s33, s28, 12582912
    s_add_u32 s34, s28, 12587008
    buffer_load_dwordx4 v[64:67], v8, s[8:11], s33 offen offset:0 nt
    buffer_load_dwordx4 v[68:71], v9, s[8:11], s33 offen offset:1024 nt
    buffer_load_dwordx4 v[72:75], v10, s[8:11], s33 offen offset:2048 nt
    buffer_load_dwordx4 v[76:79], v11, s[8:11], s33 offen offset:3072 nt
    buffer_load_dwordx4 v[80:83], v12, s[8:11], s34 offen offset:0 nt
    buffer_load_dwordx4 v[84:87], v13, s[8:11], s34 offen offset:1024 nt
    s_waitcnt vmcnt(31)
    ds_write_b128 v15, v[16:19] offset:0
    ds_write_b128 v15, v[20:23] offset:1024
    ds_write_b128 v15, v[24:27] offset:2048
    ds_write_b128 v15, v[28:31] offset:3072
    ds_write_b128 v15, v[32:35] offset:4096
    ds_write_b128 v15, v[36:39] offset:5120
    s_waitcnt vmcnt(12)
    s_waitcnt lgkmcnt(0)
    s_barrier
    s_waitcnt vmcnt(3)
    s_add_u32 s33, s28, 18874368
    s_add_u32 s34, s28, 18878464
    buffer_load_dwordx4 v[88:91], v8, s[8:11], s33 offen offset:0 nt
    s_waitcnt vmcnt(3)
    buffer_load_dwordx4 v[92:95], v9, s[8:11], s33 offen offset:1024 nt
    ds_write_b128 v15, v[40:43] offset:24576
    s_waitcnt vmcnt(3)
    buffer_load_dwordx4 v[96:99], v10, s[8:11], s33 offen offset:2048 nt
    ds_write_b128 v15, v[44:47] offset:25600
    s_waitcnt vmcnt(3)
    buffer_load_dwordx4 v[100:103], v11, s[8:11], s33 offen offset:3072 nt
    ds_write_b128 v15, v[48:51] offset:26624
    s_waitcnt vmcnt(3)
    buffer_load_dwordx4 v[104:107], v12, s[8:11], s34 offen offset:0 nt
    ds_write_b128 v15, v[52:55] offset:27648
    s_waitcnt vmcnt(3)
    buffer_load_dwordx4 v[108:111], v13, s[8:11], s34 offen offset:1024 nt
    ds_write_b128 v15, v[56:59] offset:28672
    s_waitcnt vmcnt(3)
    s_add_u32 s33, s28, 25165824
    s_add_u32 s34, s28, 25169920
    buffer_load_dwordx4 v[112:115], v8, s[8:11], s33 offen offset:0 nt
    ds_write_b128 v15, v[60:63] offset:29696
    s_waitcnt vmcnt(3)
    buffer_load_dwordx4 v[116:119], v9, s[8:11], s33 offen offset:1024 nt
    s_waitcnt lgkmcnt(0)
    s_barrier
    buffer_load_dwordx4 v[120:123], v10, s[8:11], s33 offen offset:2048 nt
    ds_read_b128 v[16:19], v14 offset:0
    ds_read_b128 v[20:23], v14 offset:1024
    ds_read_b128 v[24:27], v14 offset:2048
    ds_read_b128 v[28:31], v14 offset:3072
    ds_read_b128 v[32:35], v14 offset:4096
    ds_read_b128 v[36:39], v14 offset:5120
    buffer_load_dwordx4 v[124:127], v11, s[8:11], s33 offen offset:3072 nt
    ds_write_b128 v15, v[64:67] offset:0
    buffer_load_dwordx4 v[128:131], v12, s[8:11], s34 offen offset:0 nt
    ds_write_b128 v15, v[68:71] offset:1024
    buffer_load_dwordx4 v[132:135], v13, s[8:11], s34 offen offset:1024 nt
    ds_write_b128 v15, v[72:75] offset:2048
    s_add_u32 s33, s28, 31457280
    s_add_u32 s34, s28, 31461376
    buffer_load_dwordx4 v[136:139], v8, s[8:11], s33 offen offset:0 nt
    ds_write_b128 v15, v[76:79] offset:3072
    buffer_load_dwordx4 v[140:143], v9, s[8:11], s33 offen offset:1024 nt
    ds_write_b128 v15, v[80:83] offset:4096
    buffer_load_dwordx4 v[144:147], v10, s[8:11], s33 offen offset:2048 nt
    ds_write_b128 v15, v[84:87] offset:5120
    buffer_load_dwordx4 v[148:151], v11, s[8:11], s33 offen offset:3072 nt
    s_waitcnt lgkmcnt(0)
    s_barrier
    buffer_load_dwordx4 v[152:155], v12, s[8:11], s34 offen offset:0 nt
    ds_read_b128 v[40:43], v14 offset:24576
    ds_read_b128 v[44:47], v14 offset:25600
    ds_read_b128 v[48:51], v14 offset:26624
    ds_read_b128 v[52:55], v14 offset:27648
    ds_read_b128 v[56:59], v14 offset:28672
    ds_read_b128 v[60:63], v14 offset:29696
    buffer_load_dwordx4 v[156:159], v13, s[8:11], s34 offen offset:1024 nt
    ds_write_b128 v15, v[88:91] offset:24576
    s_add_u32 s33, s28, 37748736
    s_add_u32 s34, s28, 37752832
    buffer_load_dwordx4 v[160:163], v8, s[8:11], s33 offen offset:0 nt
    ds_write_b128 v15, v[92:95] offset:25600
    buffer_load_dwordx4 v[164:167], v9, s[8:11], s33 offen offset:1024 nt
    ds_write_b128 v15, v[96:99] offset:26624
    buffer_load_dwordx4 v[168:171], v10, s[8:11], s33 offen offset:2048 nt
    ds_write_b128 v15, v[100:103] offset:27648
    buffer_load_dwordx4 v[172:175], v11, s[8:11], s33 offen offset:3072 nt
    s_waitcnt vmcnt(17)
    ds_write_b128 v15, v[104:107] offset:28672
    buffer_load_dwordx4 v[176:179], v12, s[8:11], s34 offen offset:0 nt
    s_waitcnt vmcnt(17)
    ds_write_b128 v15, v[108:111] offset:29696
    buffer_load_dwordx4 v[180:183], v13, s[8:11], s34 offen offset:1024 nt
    s_waitcnt lgkmcnt(0)
    s_barrier
    s_add_u32 s33, s28, 44040192
    s_add_u32 s34, s28, 44044288
    buffer_load_dwordx4 v[184:187], v8, s[8:11], s33 offen offset:0 nt
    ds_read_b128 v[64:67], v14 offset:0
    ds_read_b128 v[68:71], v14 offset:1024
    ds_read_b128 v[72:75], v14 offset:2048
    ds_read_b128 v[76:79], v14 offset:3072
    ds_read_b128 v[80:83], v14 offset:4096
    ds_read_b128 v[84:87], v14 offset:5120
    buffer_load_dwordx4 v[188:191], v9, s[8:11], s33 offen offset:1024 nt
    s_waitcnt vmcnt(19)
    ds_write_b128 v15, v[112:115] offset:0
    buffer_load_dwordx4 v[192:195], v10, s[8:11], s33 offen offset:2048 nt
    s_waitcnt vmcnt(19)
    ds_write_b128 v15, v[116:119] offset:1024
    buffer_load_dwordx4 v[196:199], v11, s[8:11], s33 offen offset:3072 nt
    s_waitcnt vmcnt(19)
    ds_write_b128 v15, v[120:123] offset:2048
    buffer_load_dwordx4 v[200:203], v12, s[8:11], s34 offen offset:0 nt
    s_waitcnt vmcnt(19)
    ds_write_b128 v15, v[124:127] offset:3072
    buffer_load_dwordx4 v[204:207], v13, s[8:11], s34 offen offset:1024 nt
    s_waitcnt vmcnt(19)
    ds_write_b128 v15, v[128:131] offset:4096
    s_add_u32 s33, s28, 50331648
    s_add_u32 s34, s28, 50335744
    buffer_load_dwordx4 v[208:211], v8, s[8:11], s33 offen offset:0 nt
    s_waitcnt vmcnt(19)
    ds_write_b128 v15, v[132:135] offset:5120
    buffer_load_dwordx4 v[212:215], v9, s[8:11], s33 offen offset:1024 nt
    s_waitcnt lgkmcnt(0)
    s_barrier
    buffer_load_dwordx4 v[216:219], v10, s[8:11], s33 offen offset:2048 nt
    ds_read_b128 v[88:91], v14 offset:24576
    ds_read_b128 v[92:95], v14 offset:25600
    ds_read_b128 v[96:99], v14 offset:26624
    ds_read_b128 v[100:103], v14 offset:27648
    ds_read_b128 v[104:107], v14 offset:28672
    ds_read_b128 v[108:111], v14 offset:29696
    buffer_load_dwordx4 v[220:223], v11, s[8:11], s33 offen offset:3072 nt
    s_waitcnt vmcnt(21)
    ds_write_b128 v15, v[136:139] offset:24576
    buffer_load_dwordx4 v[224:227], v12, s[8:11], s34 offen offset:0 nt
    s_waitcnt vmcnt(21)
    ds_write_b128 v15, v[140:143] offset:25600
    buffer_load_dwordx4 v[228:231], v13, s[8:11], s34 offen offset:1024 nt
    s_waitcnt vmcnt(21)
    ds_write_b128 v15, v[144:147] offset:26624
    s_add_u32 s33, s28, 0
    s_add_u32 s34, s28, 4096
    buffer_store_dwordx4 v[16:19], v8, s[20:23], s33 offen offset:0 sc1
    s_waitcnt vmcnt(21)
    ds_write_b128 v15, v[148:151] offset:27648
    buffer_store_dwordx4 v[20:23], v9, s[20:23], s33 offen offset:1024 sc1 nt
    s_waitcnt vmcnt(21)
    ds_write_b128 v15, v[152:155] offset:28672
    buffer_store_dwordx4 v[24:27], v10, s[20:23], s33 offen offset:2048 sc1 nt
    s_waitcnt vmcnt(21)
    ds_write_b128 v15, v[156:159] offset:29696
    buffer_store_dwordx4 v[28:31], v11, s[20:23], s33 offen offset:3072 sc1
    s_waitcnt lgkmcnt(0)
    s_barrier
    buffer_store_dwordx4 v[32:35], v12, s[20:23], s34 offen offset:0 sc1 nt
    ds_read_b128 v[112:115], v14 offset:0
    ds_read_b128 v[116:119], v14 offset:1024
    ds_read_b128 v[120:123], v14 offset:2048
    ds_read_b128 v[124:127], v14 offset:3072
    ds_read_b128 v[128:131], v14 offset:4096
    ds_read_b128 v[132:135], v14 offset:5120
    buffer_store_dwordx4 v[36:39], v13, s[20:23], s34 offen offset:1024 sc1 nt
    s_waitcnt vmcnt(23)
    ds_write_b128 v15, v[160:163] offset:0
    s_add_u32 s33, s28, 6291456
    s_add_u32 s34, s28, 6295552
    buffer_store_dwordx4 v[40:43], v8, s[20:23], s33 offen offset:0 sc1
    s_waitcnt vmcnt(23)
    ds_write_b128 v15, v[164:167] offset:1024
    buffer_store_dwordx4 v[44:47], v9, s[20:23], s33 offen offset:1024 sc1 nt
    s_waitcnt vmcnt(23)
    ds_write_b128 v15, v[168:171] offset:2048
    buffer_store_dwordx4 v[48:51], v10, s[20:23], s33 offen offset:2048 sc1 nt
    s_waitcnt vmcnt(23)
    ds_write_b128 v15, v[172:175] offset:3072
    buffer_store_dwordx4 v[52:55], v11, s[20:23], s33 offen offset:3072 sc1
    s_waitcnt vmcnt(23)
    ds_write_b128 v15, v[176:179] offset:4096
    buffer_store_dwordx4 v[56:59], v12, s[20:23], s34 offen offset:0 sc1 nt
    s_waitcnt vmcnt(23)
    ds_write_b128 v15, v[180:183] offset:5120
    buffer_store_dwordx4 v[60:63], v13, s[20:23], s34 offen offset:1024 sc1 nt
    s_waitcnt lgkmcnt(0)
    s_barrier
    s_add_u32 s33, s28, 12582912
    s_add_u32 s34, s28, 12587008
    buffer_store_dwordx4 v[64:67], v8, s[20:23], s33 offen offset:0 sc1
    ds_read_b128 v[136:139], v14 offset:24576
    ds_read_b128 v[140:143], v14 offset:25600
    ds_read_b128 v[144:147], v14 offset:26624
    ds_read_b128 v[148:151], v14 offset:27648
    ds_read_b128 v[152:155], v14 offset:28672
    ds_read_b128 v[156:159], v14 offset:29696
    buffer_store_dwordx4 v[68:71], v9, s[20:23], s33 offen offset:1024 sc1 nt
    s_waitcnt vmcnt(25)
    ds_write_b128 v15, v[184:187] offset:24576
    buffer_store_dwordx4 v[72:75], v10, s[20:23], s33 offen offset:2048 sc1 nt
    s_waitcnt vmcnt(25)
    ds_write_b128 v15, v[188:191] offset:25600
    buffer_store_dwordx4 v[76:79], v11, s[20:23], s33 offen offset:3072 sc1
    s_waitcnt vmcnt(25)
    ds_write_b128 v15, v[192:195] offset:26624
    buffer_store_dwordx4 v[80:83], v12, s[20:23], s34 offen offset:0 sc1 nt
    s_waitcnt vmcnt(25)
    ds_write_b128 v15, v[196:199] offset:27648
    buffer_store_dwordx4 v[84:87], v13, s[20:23], s34 offen offset:1024 sc1 nt
    s_waitcnt vmcnt(25)
    ds_write_b128 v15, v[200:203] offset:28672
    s_add_u32 s33, s28, 18874368
    s_add_u32 s34, s28, 18878464
    buffer_store_dwordx4 v[88:91], v8, s[20:23], s33 offen offset:0 sc1
    s_waitcnt vmcnt(25)
    ds_write_b128 v15, v[204:207] offset:29696
    buffer_store_dwordx4 v[92:95], v9, s[20:23], s33 offen offset:1024 sc1 nt
    buffer_store_dwordx4 v[96:99], v10, s[20:23], s33 offen offset:2048 sc1 nt
    s_waitcnt lgkmcnt(0)
    s_barrier
    buffer_store_dwordx4 v[100:103], v11, s[20:23], s33 offen offset:3072 sc1
    ds_read_b128 v[160:163], v14 offset:0
    ds_read_b128 v[164:167], v14 offset:1024
    ds_read_b128 v[168:171], v14 offset:2048
    ds_read_b128 v[172:175], v14 offset:3072
    ds_read_b128 v[176:179], v14 offset:4096
    ds_read_b128 v[180:183], v14 offset:5120
    buffer_store_dwordx4 v[104:107], v12, s[20:23], s34 offen offset:0 sc1 nt
    s_waitcnt vmcnt(28)
    ds_write_b128 v15, v[208:211] offset:0
    buffer_store_dwordx4 v[108:111], v13, s[20:23], s34 offen offset:1024 sc1 nt
    s_waitcnt vmcnt(28)
    ds_write_b128 v15, v[212:215] offset:1024
    s_add_u32 s33, s28, 25165824
    s_add_u32 s34, s28, 25169920
    buffer_store_dwordx4 v[112:115], v8, s[20:23], s33 offen offset:0 sc1
    s_waitcnt vmcnt(28)
    ds_write_b128 v15, v[216:219] offset:2048
    buffer_store_dwordx4 v[116:119], v9, s[20:23], s33 offen offset:1024 sc1 nt
    s_waitcnt vmcnt(28)
    ds_write_b128 v15, v[220:223] offset:3072
    buffer_store_dwordx4 v[120:123], v10, s[20:23], s33 offen offset:2048 sc1 nt
    s_waitcnt vmcnt(28)
    ds_write_b128 v15, v[224:227] offset:4096
    buffer_store_dwordx4 v[124:127], v11, s[20:23], s33 offen offset:3072 sc1
    s_waitcnt vmcnt(28)
    ds_write_b128 v15, v[228:231] offset:5120
    buffer_store_dwordx4 v[128:131], v12, s[20:23], s34 offen offset:0 sc1 nt
    buffer_store_dwordx4 v[132:135], v13, s[20:23], s34 offen offset:1024 sc1 nt
    s_waitcnt lgkmcnt(0)
    s_barrier
    s_add_u32 s33, s28, 31457280
    s_add_u32 s34, s28, 31461376
    buffer_store_dwordx4 v[136:139], v8, s[20:23], s33 offen offset:0 sc1
    ds_read_b128 v[184:187], v14 offset:24576
    ds_read_b128 v[188:191], v14 offset:25600
    ds_read_b128 v[192:195], v14 offset:26624
    ds_read_b128 v[196:199], v14 offset:27648
    ds_read_b128 v[200:203], v14 offset:28672
    ds_read_b128 v[204:207], v14 offset:29696
    buffer_store_dwordx4 v[140:143], v9, s[20:23], s33 offen offset:1024 sc1 nt
    buffer_store_dwordx4 v[144:147], v10, s[20:23], s33 offen offset:2048 sc1 nt
    buffer_store_dwordx4 v[148:151], v11, s[20:23], s33 offen offset:3072 sc1
    buffer_store_dwordx4 v[152:155], v12, s[20:23], s34 offen offset:0 sc1 nt
    buffer_store_dwordx4 v[156:159], v13, s[20:23], s34 offen offset:1024 sc1 nt
    s_add_u32 s33, s28, 37748736
    s_add_u32 s34, s28, 37752832
    buffer_store_dwordx4 v[160:163], v8, s[20:23], s33 offen offset:0 sc1
    buffer_store_dwordx4 v[164:167], v9, s[20:23], s33 offen offset:1024 sc1 nt
    buffer_store_dwordx4 v[168:171], v10, s[20:23], s33 offen offset:2048 sc1 nt
    s_waitcnt lgkmcnt(0)
    s_barrier
    ds_read_b128 v[208:211], v14 offset:0
    ds_read_b128 v[212:215], v14 offset:1024
    ds_read_b128 v[216:219], v14 offset:2048
    ds_read_b128 v[220:223], v14 offset:3072
    ds_read_b128 v[224:227], v14 offset:4096
    ds_read_b128 v[228:231], v14 offset:5120
    buffer_store_dwordx4 v[172:175], v11, s[20:23], s33 offen offset:3072 sc1
    buffer_store_dwordx4 v[176:179], v12, s[20:23], s34 offen offset:0 sc1 nt
    buffer_store_dwordx4 v[180:183], v13, s[20:23], s34 offen offset:1024 sc1 nt
    s_add_u32 s33, s28, 44040192
    s_add_u32 s34, s28, 44044288
    buffer_store_dwordx4 v[184:187], v8, s[20:23], s33 offen offset:0 sc1
    buffer_store_dwordx4 v[188:191], v9, s[20:23], s33 offen offset:1024 sc1 nt
    buffer_store_dwordx4 v[192:195], v10, s[20:23], s33 offen offset:2048 sc1 nt
    buffer_store_dwordx4 v[196:199], v11, s[20:23], s33 offen offset:3072 sc1
    buffer_store_dwordx4 v[200:203], v12, s[20:23], s34 offen offset:0 sc1 nt
    buffer_store_dwordx4 v[204:207], v13, s[20:23], s34 offen offset:1024 sc1 nt
    s_add_u32 s33, s28, 50331648
    s_add_u32 s34, s28, 50335744
    s_waitcnt lgkmcnt(5)
    buffer_store_dwordx4 v[208:211], v8, s[20:23], s33 offen offset:0 sc1
    s_waitcnt lgkmcnt(4)
    buffer_store_dwordx4 v[212:215], v9, s[20:23], s33 offen offset:1024 sc1 nt
    s_waitcnt lgkmcnt(3)
    buffer_store_dwordx4 v[216:219], v10, s[20:23], s33 offen offset:2048 sc1 nt
    s_waitcnt lgkmcnt(2)
    buffer_store_dwordx4 v[220:223], v11, s[20:23], s33 offen offset:3072 sc1
    s_waitcnt lgkmcnt(1)
    buffer_store_dwordx4 v[224:227], v12, s[20:23], s34 offen offset:0 sc1 nt
    s_waitcnt lgkmcnt(0)
    buffer_store_dwordx4 v[228:231], v13, s[20:23], s34 offen offset:1024 sc1 nt
    s_endpgm
L_compute:
    s_and_b32 s28, s3, 1
    s_lshr_b32 s29, s3, 1
    s_mul_i32 s30, s28, 192
    s_add_u32 s30, s30, 147456
    v_lshrrev_b32 v5, 4, v2
    v_lshl_add_u32 v10, v5, 3, s30
    s_mul_i32 s31, s29, 12288
    v_and_b32 v6, 15, v2
    v_lshrrev_b32 v3, 1, v6
    v_and_b32 v3, 4, v3
    v_and_or_b32 v3, v6, 3, v3
    v_mul_u32_u24 v4, 384, v6
    v_add_u32 v4, s31, v4
    v_xor_b32 v8, v5, v3
    v_lshl_add_u32 v8, v8, 4, v4
    v_xor_b32 v9, 64, v8
    v_lshrrev_b32 v1, 1, v5
    v_xor_b32 v3, v3, v1
    v_lshlrev_b32 v3, 4, v3
    v_and_b32 v6, 1, v5
    v_lshl_add_u32 v4, v6, 3, v4
    v_add_u32 v4, 49152, v4
    s_mul_i32 s32, s28, 6
    s_add_u32 s33, s32, 0
    s_and_b32 s34, s33, 3
    s_lshl_b32 s86, s34, 5
    s_lshr_b32 s33, s33, 2
    s_lshl_b32 s80, s33, 7
    v_xor_b32 v12, s86, v3
    v_add3_u32 v12, v12, s80, v4
    s_add_u32 s33, s32, 1
    s_and_b32 s34, s33, 3
    s_lshl_b32 s87, s34, 5
    s_lshr_b32 s33, s33, 2
    s_lshl_b32 s81, s33, 7
    v_xor_b32 v13, s87, v3
    v_add3_u32 v13, v13, s81, v4
    s_add_u32 s33, s32, 2
    s_and_b32 s34, s33, 3
    s_lshl_b32 s88, s34, 5
    s_lshr_b32 s33, s33, 2
    s_lshl_b32 s82, s33, 7
    v_xor_b32 v14, s88, v3
    v_add3_u32 v14, v14, s82, v4
    s_add_u32 s33, s32, 3
    s_and_b32 s34, s33, 3
    s_lshl_b32 s89, s34, 5
    s_lshr_b32 s33, s33, 2
    s_lshl_b32 s83, s33, 7
    v_xor_b32 v15, s89, v3
    v_add3_u32 v15, v15, s83, v4
    s_add_u32 s33, s32, 4
    s_and_b32 s34, s33, 3
    s_lshl_b32 s90, s34, 5
    s_lshr_b32 s33, s33, 2
    s_lshl_b32 s84, s33, 7
    v_xor_b32 v16, s90, v3
    v_add3_u32 v16, v16, s84, v4
    s_add_u32 s33, s32, 5
    s_and_b32 s34, s33, 3
    s_lshl_b32 s91, s34, 5
    s_lshr_b32 s33, s33, 2
    s_lshl_b32 s85, s33, 7
    v_xor_b32 v17, s91, v3
    v_add3_u32 v17, v17, s85, v4
    v_bfe_u32 v4, v2, 2, 2
    v_lshl_add_u32 v3, v6, 2, v4
    v_lshl_add_u32 v4, v6, 3, v4
    v_mul_u32_u24 v4, 384, v4
    v_mul_u32_u24 v1, 6144, v1
    v_add_u32 v4, v4, v1
    v_bfe_u32 v1, v2, 1, 1
    v_xor_b32 v3, v3, v1
    v_lshlrev_b32 v3, 4, v3
    v_and_b32 v1, 1, v2
    v_lshl_add_u32 v4, v1, 3, v4
    v_add_u32 v4, 73728, v4
    v_xor_b32 v252, s86, v3
    v_add3_u32 v252, v252, s80, v4
    v_xor_b32 v253, s87, v3
    v_add3_u32 v253, v253, s81, v4
    v_xor_b32 v254, s88, v3
    v_add3_u32 v254, v254, s82, v4
    v_xor_b32 v255, s89, v3
    v_add3_u32 v255, v255, s83, v4
    v_xor_b32 v18, s90, v3
    v_add3_u32 v18, v18, s84, v4
    v_xor_b32 v19, s91, v3
    v_add3_u32 v19, v19, s85, v4
    s_mov_b32 s34, 0
    s_setprio 3
    s_waitcnt lgkmcnt(0)
    s_branch L_cmain
L_hg2:
    s_add_u32 s33, s28, 0
    s_add_u32 s34, s28, 4096
    buffer_load_dwordx4 v[16:19], v8, s[8:11], s33 offen offset:0 nt
    buffer_load_dwordx4 v[20:23], v9, s[8:11], s33 offen offset:1024 nt
    buffer_load_dwordx4 v[24:27], v10, s[8:11], s33 offen offset:2048 nt
    buffer_load_dwordx4 v[28:31], v11, s[8:11], s33 offen offset:3072 nt
    buffer_load_dwordx4 v[32:35], v12, s[8:11], s34 offen offset:0 nt
    buffer_load_dwordx4 v[36:39], v13, s[8:11], s34 offen offset:1024 nt
    s_add_u32 s33, s28, 6291456
    s_add_u32 s34, s28, 6295552
    buffer_load_dwordx4 v[40:43], v8, s[8:11], s33 offen offset:0 nt
    buffer_load_dwordx4 v[44:47], v9, s[8:11], s33 offen offset:1024 nt
    buffer_load_dwordx4 v[48:51], v10, s[8:11], s33 offen offset:2048 nt
    buffer_load_dwordx4 v[52:55], v11, s[8:11], s33 offen offset:3072 nt
    buffer_load_dwordx4 v[56:59], v12, s[8:11], s34 offen offset:0 nt
    buffer_load_dwordx4 v[60:63], v13, s[8:11], s34 offen offset:1024 nt
    s_mov_b32 m0, 147456
    s_nop 0
    buffer_load_dwordx4 v7, s[16:19], 0 offen lds
    s_add_u32 m0, s44, 73728
    s_add_u32 s31, s44, 0
    buffer_load_dwordx4 v8, s[12:15], s31 offen offset:0 lds
    buffer_load_dwordx4 v9, s[12:15], s31 offen offset:1024 lds
    buffer_load_dwordx4 v10, s[12:15], s31 offen offset:2048 lds
    buffer_load_dwordx4 v11, s[12:15], s31 offen offset:3072 lds
    s_add_u32 m0, s44, 77824
    s_add_u32 s31, s44, 4096
    buffer_load_dwordx4 v12, s[12:15], s31 offen offset:0 lds
    buffer_load_dwordx4 v13, s[12:15], s31 offen offset:1024 lds
    s_add_u32 m0, s45, 73728
    s_add_u32 s31, s45, 0
    buffer_load_dwordx4 v8, s[12:15], s31 offen offset:0 lds
    buffer_load_dwordx4 v9, s[12:15], s31 offen offset:1024 lds
    buffer_load_dwordx4 v10, s[12:15], s31 offen offset:2048 lds
    buffer_load_dwordx4 v11, s[12:15], s31 offen offset:3072 lds
    s_add_u32 m0, s45, 77824
    s_add_u32 s31, s45, 4096
    buffer_load_dwordx4 v12, s[12:15], s31 offen offset:0 lds
    buffer_load_dwordx4 v13, s[12:15], s31 offen offset:1024 lds
    s_add_u32 m0, s46, 73728
    s_add_u32 s31, s46, 0
    buffer_load_dwordx4 v8, s[12:15], s31 offen offset:0 lds
    buffer_load_dwordx4 v9, s[12:15], s31 offen offset:1024 lds
    buffer_load_dwordx4 v10, s[12:15], s31 offen offset:2048 lds
    buffer_load_dwordx4 v11, s[12:15], s31 offen offset:3072 lds
    s_add_u32 m0, s46, 77824
    s_add_u32 s31, s46, 4096
    buffer_load_dwordx4 v12, s[12:15], s31 offen offset:0 lds
    buffer_load_dwordx4 v13, s[12:15], s31 offen offset:1024 lds
    s_add_u32 s33, s28, 12582912
    s_add_u32 s34, s28, 12587008
    buffer_load_dwordx4 v[64:67], v8, s[8:11], s33 offen offset:0 nt
    buffer_load_dwordx4 v[68:71], v9, s[8:11], s33 offen offset:1024 nt
    buffer_load_dwordx4 v[72:75], v10, s[8:11], s33 offen offset:2048 nt
    buffer_load_dwordx4 v[76:79], v11, s[8:11], s33 offen offset:3072 nt
    buffer_load_dwordx4 v[80:83], v12, s[8:11], s34 offen offset:0 nt
    buffer_load_dwordx4 v[84:87], v13, s[8:11], s34 offen offset:1024 nt
    s_add_u32 s33, s28, 18874368
    s_add_u32 s34, s28, 18878464
    buffer_load_dwordx4 v[88:91], v8, s[8:11], s33 offen offset:0 nt
    buffer_load_dwordx4 v[92:95], v9, s[8:11], s33 offen offset:1024 nt
    buffer_load_dwordx4 v[96:99], v10, s[8:11], s33 offen offset:2048 nt
    buffer_load_dwordx4 v[100:103], v11, s[8:11], s33 offen offset:3072 nt
    buffer_load_dwordx4 v[104:107], v12, s[8:11], s34 offen offset:0 nt
    buffer_load_dwordx4 v[108:111], v13, s[8:11], s34 offen offset:1024 nt
    s_waitcnt vmcnt(37)
    ds_write_b128 v15, v[16:19] offset:0
    ds_write_b128 v15, v[20:23] offset:1024
    ds_write_b128 v15, v[24:27] offset:2048
    ds_write_b128 v15, v[28:31] offset:3072
    ds_write_b128 v15, v[32:35] offset:4096
    ds_write_b128 v15, v[36:39] offset:5120
    s_waitcnt vmcnt(12)
    s_waitcnt lgkmcnt(0)
    s_barrier
    s_waitcnt vmcnt(3)
    s_add_u32 s33, s28, 25165824
    s_add_u32 s34, s28, 25169920
    buffer_load_dwordx4 v[112:115], v8, s[8:11], s33 offen offset:0 nt
    s_waitcnt vmcnt(3)
    buffer_load_dwordx4 v[116:119], v9, s[8:11], s33 offen offset:1024 nt
    ds_write_b128 v15, v[40:43] offset:24576
    s_waitcnt vmcnt(3)
    buffer_load_dwordx4 v[120:123], v10, s[8:11], s33 offen offset:2048 nt
    ds_write_b128 v15, v[44:47] offset:25600
    s_waitcnt vmcnt(3)
    buffer_load_dwordx4 v[124:127], v11, s[8:11], s33 offen offset:3072 nt
    ds_write_b128 v15, v[48:51] offset:26624
    s_waitcnt vmcnt(3)
    buffer_load_dwordx4 v[128:131], v12, s[8:11], s34 offen offset:0 nt
    ds_write_b128 v15, v[52:55] offset:27648
    s_waitcnt vmcnt(3)
    buffer_load_dwordx4 v[132:135], v13, s[8:11], s34 offen offset:1024 nt
    ds_write_b128 v15, v[56:59] offset:28672
    s_waitcnt vmcnt(3)
    s_add_u32 s33, s28, 31457280
    s_add_u32 s34, s28, 31461376
    buffer_load_dwordx4 v[136:139], v8, s[8:11], s33 offen offset:0 nt
    ds_write_b128 v15, v[60:63] offset:29696
    s_waitcnt vmcnt(3)
    buffer_load_dwordx4 v[140:143], v9, s[8:11], s33 offen offset:1024 nt
    s_waitcnt lgkmcnt(0)
    s_barrier
    buffer_load_dwordx4 v[144:147], v10, s[8:11], s33 offen offset:2048 nt
    ds_read_b128 v[16:19], v14 offset:0
    ds_read_b128 v[20:23], v14 offset:1024
    ds_read_b128 v[24:27], v14 offset:2048
    ds_read_b128 v[28:31], v14 offset:3072
    ds_read_b128 v[32:35], v14 offset:4096
    ds_read_b128 v[36:39], v14 offset:5120
    buffer_load_dwordx4 v[148:151], v11, s[8:11], s33 offen offset:3072 nt
    ds_write_b128 v15, v[64:67] offset:0
    buffer_load_dwordx4 v[152:155], v12, s[8:11], s34 offen offset:0 nt
    ds_write_b128 v15, v[68:71] offset:1024
    buffer_load_dwordx4 v[156:159], v13, s[8:11], s34 offen offset:1024 nt
    ds_write_b128 v15, v[72:75] offset:2048
    s_add_u32 s33, s28, 37748736
    s_add_u32 s34, s28, 37752832
    buffer_load_dwordx4 v[160:163], v8, s[8:11], s33 offen offset:0 nt
    ds_write_b128 v15, v[76:79] offset:3072
    buffer_load_dwordx4 v[164:167], v9, s[8:11], s33 offen offset:1024 nt
    ds_write_b128 v15, v[80:83] offset:4096
    buffer_load_dwordx4 v[168:171], v10, s[8:11], s33 offen offset:2048 nt
    ds_write_b128 v15, v[84:87] offset:5120
    buffer_load_dwordx4 v[172:175], v11, s[8:11], s33 offen offset:3072 nt
    s_waitcnt lgkmcnt(0)
    s_barrier
    buffer_load_dwordx4 v[176:179], v12, s[8:11], s34 offen offset:0 nt
    ds_read_b128 v[40:43], v14 offset:24576
    ds_read_b128 v[44:47], v14 offset:25600
    ds_read_b128 v[48:51], v14 offset:26624
    ds_read_b128 v[52:55], v14 offset:27648
    ds_read_b128 v[56:59], v14 offset:28672
    ds_read_b128 v[60:63], v14 offset:29696
    buffer_load_dwordx4 v[180:183], v13, s[8:11], s34 offen offset:1024 nt
    ds_write_b128 v15, v[88:91] offset:24576
    s_add_u32 s33, s28, 44040192
    s_add_u32 s34, s28, 44044288
    buffer_load_dwordx4 v[184:187], v8, s[8:11], s33 offen offset:0 nt
    ds_write_b128 v15, v[92:95] offset:25600
    buffer_load_dwordx4 v[188:191], v9, s[8:11], s33 offen offset:1024 nt
    ds_write_b128 v15, v[96:99] offset:26624
    buffer_load_dwordx4 v[192:195], v10, s[8:11], s33 offen offset:2048 nt
    ds_write_b128 v15, v[100:103] offset:27648
    buffer_load_dwordx4 v[196:199], v11, s[8:11], s33 offen offset:3072 nt
    ds_write_b128 v15, v[104:107] offset:28672
    buffer_load_dwordx4 v[200:203], v12, s[8:11], s34 offen offset:0 nt
    ds_write_b128 v15, v[108:111] offset:29696
    buffer_load_dwordx4 v[204:207], v13, s[8:11], s34 offen offset:1024 nt
    s_waitcnt lgkmcnt(0)
    s_barrier
    s_add_u32 s33, s28, 50331648
    s_add_u32 s34, s28, 50335744
    buffer_load_dwordx4 v[208:211], v8, s[8:11], s33 offen offset:0 nt
    ds_read_b128 v[64:67], v14 offset:0
    ds_read_b128 v[68:71], v14 offset:1024
    ds_read_b128 v[72:75], v14 offset:2048
    ds_read_b128 v[76:79], v14 offset:3072
    ds_read_b128 v[80:83], v14 offset:4096
    ds_read_b128 v[84:87], v14 offset:5120
    buffer_load_dwordx4 v[212:215], v9, s[8:11], s33 offen offset:1024 nt
    ds_write_b128 v15, v[112:115] offset:0
    buffer_load_dwordx4 v[216:219], v10, s[8:11], s33 offen offset:2048 nt
    ds_write_b128 v15, v[116:119] offset:1024
    buffer_load_dwordx4 v[220:223], v11, s[8:11], s33 offen offset:3072 nt
    ds_write_b128 v15, v[120:123] offset:2048
    buffer_load_dwordx4 v[224:227], v12, s[8:11], s34 offen offset:0 nt
    ds_write_b128 v15, v[124:127] offset:3072
    buffer_load_dwordx4 v[228:231], v13, s[8:11], s34 offen offset:1024 nt
    s_waitcnt vmcnt(25)
    ds_write_b128 v15, v[128:131] offset:4096
    s_add_u32 s33, s28, 0
    s_add_u32 s34, s28, 4096
    buffer_store_dwordx4 v[16:19], v8, s[20:23], s33 offen offset:0 sc1
    s_waitcnt vmcnt(25)
    ds_write_b128 v15, v[132:135] offset:5120
    buffer_store_dwordx4 v[20:23], v9, s[20:23], s33 offen offset:1024 sc1 nt
    s_waitcnt lgkmcnt(0)
    s_barrier
    buffer_store_dwordx4 v[24:27], v10, s[20:23], s33 offen offset:2048 sc1 nt
    ds_read_b128 v[88:91], v14 offset:24576
    ds_read_b128 v[92:95], v14 offset:25600
    ds_read_b128 v[96:99], v14 offset:26624
    ds_read_b128 v[100:103], v14 offset:27648
    ds_read_b128 v[104:107], v14 offset:28672
    ds_read_b128 v[108:111], v14 offset:29696
    buffer_store_dwordx4 v[28:31], v11, s[20:23], s33 offen offset:3072 sc1
    s_waitcnt vmcnt(27)
    ds_write_b128 v15, v[136:139] offset:24576
    buffer_store_dwordx4 v[32:35], v12, s[20:23], s34 offen offset:0 sc1 nt
    s_waitcnt vmcnt(27)
    ds_write_b128 v15, v[140:143] offset:25600
    buffer_store_dwordx4 v[36:39], v13, s[20:23], s34 offen offset:1024 sc1 nt
    s_waitcnt vmcnt(27)
    ds_write_b128 v15, v[144:147] offset:26624
    s_add_u32 s33, s28, 6291456
    s_add_u32 s34, s28, 6295552
    buffer_store_dwordx4 v[40:43], v8, s[20:23], s33 offen offset:0 sc1
    s_waitcnt vmcnt(27)
    ds_write_b128 v15, v[148:151] offset:27648
    buffer_store_dwordx4 v[44:47], v9, s[20:23], s33 offen offset:1024 sc1 nt
    s_waitcnt vmcnt(27)
    ds_write_b128 v15, v[152:155] offset:28672
    buffer_store_dwordx4 v[48:51], v10, s[20:23], s33 offen offset:2048 sc1 nt
    s_waitcnt vmcnt(27)
    ds_write_b128 v15, v[156:159] offset:29696
    buffer_store_dwordx4 v[52:55], v11, s[20:23], s33 offen offset:3072 sc1
    s_waitcnt lgkmcnt(0)
    s_barrier
    buffer_store_dwordx4 v[56:59], v12, s[20:23], s34 offen offset:0 sc1 nt
    ds_read_b128 v[112:115], v14 offset:0
    ds_read_b128 v[116:119], v14 offset:1024
    ds_read_b128 v[120:123], v14 offset:2048
    ds_read_b128 v[124:127], v14 offset:3072
    ds_read_b128 v[128:131], v14 offset:4096
    ds_read_b128 v[132:135], v14 offset:5120
    buffer_store_dwordx4 v[60:63], v13, s[20:23], s34 offen offset:1024 sc1 nt
    s_waitcnt vmcnt(29)
    ds_write_b128 v15, v[160:163] offset:0
    s_add_u32 s33, s28, 12582912
    s_add_u32 s34, s28, 12587008
    buffer_store_dwordx4 v[64:67], v8, s[20:23], s33 offen offset:0 sc1
    s_waitcnt vmcnt(29)
    ds_write_b128 v15, v[164:167] offset:1024
    buffer_store_dwordx4 v[68:71], v9, s[20:23], s33 offen offset:1024 sc1 nt
    s_waitcnt vmcnt(29)
    ds_write_b128 v15, v[168:171] offset:2048
    buffer_store_dwordx4 v[72:75], v10, s[20:23], s33 offen offset:2048 sc1 nt
    s_waitcnt vmcnt(29)
    ds_write_b128 v15, v[172:175] offset:3072
    buffer_store_dwordx4 v[76:79], v11, s[20:23], s33 offen offset:3072 sc1
    s_waitcnt vmcnt(29)
    ds_write_b128 v15, v[176:179] offset:4096
    buffer_store_dwordx4 v[80:83], v12, s[20:23], s34 offen offset:0 sc1 nt
    s_waitcnt vmcnt(29)
    ds_write_b128 v15, v[180:183] offset:5120
    buffer_store_dwordx4 v[84:87], v13, s[20:23], s34 offen offset:1024 sc1 nt
    s_waitcnt lgkmcnt(0)
    s_barrier
    s_add_u32 s33, s28, 18874368
    s_add_u32 s34, s28, 18878464
    buffer_store_dwordx4 v[88:91], v8, s[20:23], s33 offen offset:0 sc1
    ds_read_b128 v[136:139], v14 offset:24576
    ds_read_b128 v[140:143], v14 offset:25600
    ds_read_b128 v[144:147], v14 offset:26624
    ds_read_b128 v[148:151], v14 offset:27648
    ds_read_b128 v[152:155], v14 offset:28672
    ds_read_b128 v[156:159], v14 offset:29696
    buffer_store_dwordx4 v[92:95], v9, s[20:23], s33 offen offset:1024 sc1 nt
    s_waitcnt vmcnt(31)
    ds_write_b128 v15, v[184:187] offset:24576
    buffer_store_dwordx4 v[96:99], v10, s[20:23], s33 offen offset:2048 sc1 nt
    s_waitcnt vmcnt(31)
    ds_write_b128 v15, v[188:191] offset:25600
    buffer_store_dwordx4 v[100:103], v11, s[20:23], s33 offen offset:3072 sc1
    s_waitcnt vmcnt(31)
    ds_write_b128 v15, v[192:195] offset:26624
    buffer_store_dwordx4 v[104:107], v12, s[20:23], s34 offen offset:0 sc1 nt
    s_waitcnt vmcnt(31)
    ds_write_b128 v15, v[196:199] offset:27648
    buffer_store_dwordx4 v[108:111], v13, s[20:23], s34 offen offset:1024 sc1 nt
    s_waitcnt vmcnt(31)
    ds_write_b128 v15, v[200:203] offset:28672
    s_add_u32 s33, s28, 25165824
    s_add_u32 s34, s28, 25169920
    buffer_store_dwordx4 v[112:115], v8, s[20:23], s33 offen offset:0 sc1
    s_waitcnt vmcnt(31)
    ds_write_b128 v15, v[204:207] offset:29696
    buffer_store_dwordx4 v[116:119], v9, s[20:23], s33 offen offset:1024 sc1 nt
    buffer_store_dwordx4 v[120:123], v10, s[20:23], s33 offen offset:2048 sc1 nt
    s_waitcnt lgkmcnt(0)
    s_barrier
    buffer_store_dwordx4 v[124:127], v11, s[20:23], s33 offen offset:3072 sc1
    ds_read_b128 v[160:163], v14 offset:0
    ds_read_b128 v[164:167], v14 offset:1024
    ds_read_b128 v[168:171], v14 offset:2048
    ds_read_b128 v[172:175], v14 offset:3072
    ds_read_b128 v[176:179], v14 offset:4096
    ds_read_b128 v[180:183], v14 offset:5120
    buffer_store_dwordx4 v[128:131], v12, s[20:23], s34 offen offset:0 sc1 nt
    s_waitcnt vmcnt(34)
    ds_write_b128 v15, v[208:211] offset:0
    buffer_store_dwordx4 v[132:135], v13, s[20:23], s34 offen offset:1024 sc1 nt
    s_waitcnt vmcnt(34)
    ds_write_b128 v15, v[212:215] offset:1024
    s_add_u32 s33, s28, 31457280
    s_add_u32 s34, s28, 31461376
    buffer_store_dwordx4 v[136:139], v8, s[20:23], s33 offen offset:0 sc1
    s_waitcnt vmcnt(34)
    ds_write_b128 v15, v[216:219] offset:2048
    buffer_store_dwordx4 v[140:143], v9, s[20:23], s33 offen offset:1024 sc1 nt
    s_waitcnt vmcnt(34)
    ds_write_b128 v15, v[220:223] offset:3072
    buffer_store_dwordx4 v[144:147], v10, s[20:23], s33 offen offset:2048 sc1 nt
    s_waitcnt vmcnt(34)
    ds_write_b128 v15, v[224:227] offset:4096
    buffer_store_dwordx4 v[148:151], v11, s[20:23], s33 offen offset:3072 sc1
    s_waitcnt vmcnt(34)
    ds_write_b128 v15, v[228:231] offset:5120
    buffer_store_dwordx4 v[152:155], v12, s[20:23], s34 offen offset:0 sc1 nt
    buffer_store_dwordx4 v[156:159], v13, s[20:23], s34 offen offset:1024 sc1 nt
    s_waitcnt lgkmcnt(0)
    s_barrier
    s_add_u32 s33, s28, 37748736
    s_add_u32 s34, s28, 37752832
    buffer_store_dwordx4 v[160:163], v8, s[20:23], s33 offen offset:0 sc1
    ds_read_b128 v[184:187], v14 offset:24576
    ds_read_b128 v[188:191], v14 offset:25600
    ds_read_b128 v[192:195], v14 offset:26624
    ds_read_b128 v[196:199], v14 offset:27648
    ds_read_b128 v[200:203], v14 offset:28672
    ds_read_b128 v[204:207], v14 offset:29696
    buffer_store_dwordx4 v[164:167], v9, s[20:23], s33 offen offset:1024 sc1 nt
    buffer_store_dwordx4 v[168:171], v10, s[20:23], s33 offen offset:2048 sc1 nt
    buffer_store_dwordx4 v[172:175], v11, s[20:23], s33 offen offset:3072 sc1
    buffer_store_dwordx4 v[176:179], v12, s[20:23], s34 offen offset:0 sc1 nt
    buffer_store_dwordx4 v[180:183], v13, s[20:23], s34 offen offset:1024 sc1 nt
    s_add_u32 s33, s28, 44040192
    s_add_u32 s34, s28, 44044288
    s_waitcnt lgkmcnt(5)
    buffer_store_dwordx4 v[184:187], v8, s[20:23], s33 offen offset:0 sc1
    s_waitcnt lgkmcnt(4)
    buffer_store_dwordx4 v[188:191], v9, s[20:23], s33 offen offset:1024 sc1 nt
    s_waitcnt lgkmcnt(3)
    buffer_store_dwordx4 v[192:195], v10, s[20:23], s33 offen offset:2048 sc1 nt
    s_waitcnt lgkmcnt(0)
    s_barrier
    ds_read_b128 v[208:211], v14 offset:0
    ds_read_b128 v[212:215], v14 offset:1024
    ds_read_b128 v[216:219], v14 offset:2048
    ds_read_b128 v[220:223], v14 offset:3072
    ds_read_b128 v[224:227], v14 offset:4096
    ds_read_b128 v[228:231], v14 offset:5120
    buffer_store_dwordx4 v[196:199], v11, s[20:23], s33 offen offset:3072 sc1
    buffer_store_dwordx4 v[200:203], v12, s[20:23], s34 offen offset:0 sc1 nt
    buffer_store_dwordx4 v[204:207], v13, s[20:23], s34 offen offset:1024 sc1 nt
    s_add_u32 s33, s28, 50331648
    s_add_u32 s34, s28, 50335744
    s_waitcnt lgkmcnt(5)
    buffer_store_dwordx4 v[208:211], v8, s[20:23], s33 offen offset:0 sc1
    s_waitcnt lgkmcnt(4)
    buffer_store_dwordx4 v[212:215], v9, s[20:23], s33 offen offset:1024 sc1 nt
    s_waitcnt lgkmcnt(3)
    buffer_store_dwordx4 v[216:219], v10, s[20:23], s33 offen offset:2048 sc1 nt
    s_waitcnt lgkmcnt(2)
    buffer_store_dwordx4 v[220:223], v11, s[20:23], s33 offen offset:3072 sc1
    s_waitcnt lgkmcnt(1)
    buffer_store_dwordx4 v[224:227], v12, s[20:23], s34 offen offset:0 sc1 nt
    s_waitcnt lgkmcnt(0)
    buffer_store_dwordx4 v[228:231], v13, s[20:23], s34 offen offset:1024 sc1 nt
    s_endpgm
L_hg3:
    s_add_u32 s33, s28, 0
    s_add_u32 s34, s28, 4096
    buffer_load_dwordx4 v[16:19], v8, s[8:11], s33 offen offset:0 nt
    buffer_load_dwordx4 v[20:23], v9, s[8:11], s33 offen offset:1024 nt
    buffer_load_dwordx4 v[24:27], v10, s[8:11], s33 offen offset:2048 nt
    buffer_load_dwordx4 v[28:31], v11, s[8:11], s33 offen offset:3072 nt
    buffer_load_dwordx4 v[32:35], v12, s[8:11], s34 offen offset:0 nt
    buffer_load_dwordx4 v[36:39], v13, s[8:11], s34 offen offset:1024 nt
    s_add_u32 s33, s28, 6291456
    s_add_u32 s34, s28, 6295552
    buffer_load_dwordx4 v[40:43], v8, s[8:11], s33 offen offset:0 nt
    buffer_load_dwordx4 v[44:47], v9, s[8:11], s33 offen offset:1024 nt
    buffer_load_dwordx4 v[48:51], v10, s[8:11], s33 offen offset:2048 nt
    buffer_load_dwordx4 v[52:55], v11, s[8:11], s33 offen offset:3072 nt
    buffer_load_dwordx4 v[56:59], v12, s[8:11], s34 offen offset:0 nt
    buffer_load_dwordx4 v[60:63], v13, s[8:11], s34 offen offset:1024 nt
    s_add_u32 s33, s28, 12582912
    s_add_u32 s34, s28, 12587008
    buffer_load_dwordx4 v[64:67], v8, s[8:11], s33 offen offset:0 nt
    buffer_load_dwordx4 v[68:71], v9, s[8:11], s33 offen offset:1024 nt
    buffer_load_dwordx4 v[72:75], v10, s[8:11], s33 offen offset:2048 nt
    buffer_load_dwordx4 v[76:79], v11, s[8:11], s33 offen offset:3072 nt
    buffer_load_dwordx4 v[80:83], v12, s[8:11], s34 offen offset:0 nt
    buffer_load_dwordx4 v[84:87], v13, s[8:11], s34 offen offset:1024 nt
    s_mov_b32 m0, 147456
    s_nop 0
    buffer_load_dwordx4 v7, s[16:19], 0 offen lds
    s_add_u32 m0, s44, 73728
    s_add_u32 s31, s44, 0
    buffer_load_dwordx4 v8, s[12:15], s31 offen offset:0 lds
    buffer_load_dwordx4 v9, s[12:15], s31 offen offset:1024 lds
    buffer_load_dwordx4 v10, s[12:15], s31 offen offset:2048 lds
    buffer_load_dwordx4 v11, s[12:15], s31 offen offset:3072 lds
    s_add_u32 m0, s44, 77824
    s_add_u32 s31, s44, 4096
    buffer_load_dwordx4 v12, s[12:15], s31 offen offset:0 lds
    buffer_load_dwordx4 v13, s[12:15], s31 offen offset:1024 lds
    s_add_u32 m0, s45, 73728
    s_add_u32 s31, s45, 0
    buffer_load_dwordx4 v8, s[12:15], s31 offen offset:0 lds
    buffer_load_dwordx4 v9, s[12:15], s31 offen offset:1024 lds
    buffer_load_dwordx4 v10, s[12:15], s31 offen offset:2048 lds
    buffer_load_dwordx4 v11, s[12:15], s31 offen offset:3072 lds
    s_add_u32 m0, s45, 77824
    s_add_u32 s31, s45, 4096
    buffer_load_dwordx4 v12, s[12:15], s31 offen offset:0 lds
    buffer_load_dwordx4 v13, s[12:15], s31 offen offset:1024 lds
    s_add_u32 m0, s46, 73728
    s_add_u32 s31, s46, 0
    buffer_load_dwordx4 v8, s[12:15], s31 offen offset:0 lds
    buffer_load_dwordx4 v9, s[12:15], s31 offen offset:1024 lds
    buffer_load_dwordx4 v10, s[12:15], s31 offen offset:2048 lds
    buffer_load_dwordx4 v11, s[12:15], s31 offen offset:3072 lds
    s_add_u32 m0, s46, 77824
    s_add_u32 s31, s46, 4096
    buffer_load_dwordx4 v12, s[12:15], s31 offen offset:0 lds
    buffer_load_dwordx4 v13, s[12:15], s31 offen offset:1024 lds
    s_add_u32 s33, s28, 18874368
    s_add_u32 s34, s28, 18878464
    buffer_load_dwordx4 v[88:91], v8, s[8:11], s33 offen offset:0 nt
    buffer_load_dwordx4 v[92:95], v9, s[8:11], s33 offen offset:1024 nt
    buffer_load_dwordx4 v[96:99], v10, s[8:11], s33 offen offset:2048 nt
    buffer_load_dwordx4 v[100:103], v11, s[8:11], s33 offen offset:3072 nt
    buffer_load_dwordx4 v[104:107], v12, s[8:11], s34 offen offset:0 nt
    buffer_load_dwordx4 v[108:111], v13, s[8:11], s34 offen offset:1024 nt
    s_add_u32 s33, s28, 25165824
    s_add_u32 s34, s28, 25169920
    buffer_load_dwordx4 v[112:115], v8, s[8:11], s33 offen offset:0 nt
    buffer_load_dwordx4 v[116:119], v9, s[8:11], s33 offen offset:1024 nt
    buffer_load_dwordx4 v[120:123], v10, s[8:11], s33 offen offset:2048 nt
    buffer_load_dwordx4 v[124:127], v11, s[8:11], s33 offen offset:3072 nt
    buffer_load_dwordx4 v[128:131], v12, s[8:11], s34 offen offset:0 nt
    buffer_load_dwordx4 v[132:135], v13, s[8:11], s34 offen offset:1024 nt
    s_waitcnt vmcnt(43)
    ds_write_b128 v15, v[16:19] offset:0
    ds_write_b128 v15, v[20:23] offset:1024
    ds_write_b128 v15, v[24:27] offset:2048
    ds_write_b128 v15, v[28:31] offset:3072
    ds_write_b128 v15, v[32:35] offset:4096
    ds_write_b128 v15, v[36:39] offset:5120
    s_waitcnt vmcnt(12)
    s_waitcnt lgkmcnt(0)
    s_barrier
    s_waitcnt vmcnt(3)
    s_add_u32 s33, s28, 31457280
    s_add_u32 s34, s28, 31461376
    buffer_load_dwordx4 v[136:139], v8, s[8:11], s33 offen offset:0 nt
    s_waitcnt vmcnt(3)
    buffer_load_dwordx4 v[140:143], v9, s[8:11], s33 offen offset:1024 nt
    ds_write_b128 v15, v[40:43] offset:24576
    s_waitcnt vmcnt(3)
    buffer_load_dwordx4 v[144:147], v10, s[8:11], s33 offen offset:2048 nt
    ds_write_b128 v15, v[44:47] offset:25600
    s_waitcnt vmcnt(3)
    buffer_load_dwordx4 v[148:151], v11, s[8:11], s33 offen offset:3072 nt
    ds_write_b128 v15, v[48:51] offset:26624
    s_waitcnt vmcnt(3)
    buffer_load_dwordx4 v[152:155], v12, s[8:11], s34 offen offset:0 nt
    ds_write_b128 v15, v[52:55] offset:27648
    s_waitcnt vmcnt(3)
    buffer_load_dwordx4 v[156:159], v13, s[8:11], s34 offen offset:1024 nt
    ds_write_b128 v15, v[56:59] offset:28672
    s_waitcnt vmcnt(3)
    s_add_u32 s33, s28, 37748736
    s_add_u32 s34, s28, 37752832
    buffer_load_dwordx4 v[160:163], v8, s[8:11], s33 offen offset:0 nt
    ds_write_b128 v15, v[60:63] offset:29696
    s_waitcnt vmcnt(3)
    buffer_load_dwordx4 v[164:167], v9, s[8:11], s33 offen offset:1024 nt
    s_waitcnt lgkmcnt(0)
    s_barrier
    buffer_load_dwordx4 v[168:171], v10, s[8:11], s33 offen offset:2048 nt
    ds_read_b128 v[16:19], v14 offset:0
    ds_read_b128 v[20:23], v14 offset:1024
    ds_read_b128 v[24:27], v14 offset:2048
    ds_read_b128 v[28:31], v14 offset:3072
    ds_read_b128 v[32:35], v14 offset:4096
    ds_read_b128 v[36:39], v14 offset:5120
    buffer_load_dwordx4 v[172:175], v11, s[8:11], s33 offen offset:3072 nt
    ds_write_b128 v15, v[64:67] offset:0
    buffer_load_dwordx4 v[176:179], v12, s[8:11], s34 offen offset:0 nt
    ds_write_b128 v15, v[68:71] offset:1024
    buffer_load_dwordx4 v[180:183], v13, s[8:11], s34 offen offset:1024 nt
    ds_write_b128 v15, v[72:75] offset:2048
    s_add_u32 s33, s28, 44040192
    s_add_u32 s34, s28, 44044288
    buffer_load_dwordx4 v[184:187], v8, s[8:11], s33 offen offset:0 nt
    ds_write_b128 v15, v[76:79] offset:3072
    buffer_load_dwordx4 v[188:191], v9, s[8:11], s33 offen offset:1024 nt
    ds_write_b128 v15, v[80:83] offset:4096
    buffer_load_dwordx4 v[192:195], v10, s[8:11], s33 offen offset:2048 nt
    ds_write_b128 v15, v[84:87] offset:5120
    buffer_load_dwordx4 v[196:199], v11, s[8:11], s33 offen offset:3072 nt
    s_waitcnt lgkmcnt(0)
    s_barrier
    buffer_load_dwordx4 v[200:203], v12, s[8:11], s34 offen offset:0 nt
    ds_read_b128 v[40:43], v14 offset:24576
    ds_read_b128 v[44:47], v14 offset:25600
    ds_read_b128 v[48:51], v14 offset:26624
    ds_read_b128 v[52:55], v14 offset:27648
    ds_read_b128 v[56:59], v14 offset:28672
    ds_read_b128 v[60:63], v14 offset:29696
    buffer_load_dwordx4 v[204:207], v13, s[8:11], s34 offen offset:1024 nt
    ds_write_b128 v15, v[88:91] offset:24576
    s_add_u32 s33, s28, 50331648
    s_add_u32 s34, s28, 50335744
    buffer_load_dwordx4 v[208:211], v8, s[8:11], s33 offen offset:0 nt
    ds_write_b128 v15, v[92:95] offset:25600
    buffer_load_dwordx4 v[212:215], v9, s[8:11], s33 offen offset:1024 nt
    ds_write_b128 v15, v[96:99] offset:26624
    buffer_load_dwordx4 v[216:219], v10, s[8:11], s33 offen offset:2048 nt
    ds_write_b128 v15, v[100:103] offset:27648
    buffer_load_dwordx4 v[220:223], v11, s[8:11], s33 offen offset:3072 nt
    ds_write_b128 v15, v[104:107] offset:28672
    buffer_load_dwordx4 v[224:227], v12, s[8:11], s34 offen offset:0 nt
    ds_write_b128 v15, v[108:111] offset:29696
    buffer_load_dwordx4 v[228:231], v13, s[8:11], s34 offen offset:1024 nt
    s_waitcnt lgkmcnt(0)
    s_barrier
    s_add_u32 s33, s28, 0
    s_add_u32 s34, s28, 4096
    buffer_store_dwordx4 v[16:19], v8, s[20:23], s33 offen offset:0 sc1
    ds_read_b128 v[64:67], v14 offset:0
    ds_read_b128 v[68:71], v14 offset:1024
    ds_read_b128 v[72:75], v14 offset:2048
    ds_read_b128 v[76:79], v14 offset:3072
    ds_read_b128 v[80:83], v14 offset:4096
    ds_read_b128 v[84:87], v14 offset:5120
    buffer_store_dwordx4 v[20:23], v9, s[20:23], s33 offen offset:1024 sc1 nt
    ds_write_b128 v15, v[112:115] offset:0
    buffer_store_dwordx4 v[24:27], v10, s[20:23], s33 offen offset:2048 sc1 nt
    ds_write_b128 v15, v[116:119] offset:1024
    buffer_store_dwordx4 v[28:31], v11, s[20:23], s33 offen offset:3072 sc1
    ds_write_b128 v15, v[120:123] offset:2048
    buffer_store_dwordx4 v[32:35], v12, s[20:23], s34 offen offset:0 sc1 nt
    ds_write_b128 v15, v[124:127] offset:3072
    buffer_store_dwordx4 v[36:39], v13, s[20:23], s34 offen offset:1024 sc1 nt
    ds_write_b128 v15, v[128:131] offset:4096
    s_add_u32 s33, s28, 6291456
    s_add_u32 s34, s28, 6295552
    buffer_store_dwordx4 v[40:43], v8, s[20:23], s33 offen offset:0 sc1
    ds_write_b128 v15, v[132:135] offset:5120
    buffer_store_dwordx4 v[44:47], v9, s[20:23], s33 offen offset:1024 sc1 nt
    s_waitcnt lgkmcnt(0)
    s_barrier
    buffer_store_dwordx4 v[48:51], v10, s[20:23], s33 offen offset:2048 sc1 nt
    ds_read_b128 v[88:91], v14 offset:24576
    ds_read_b128 v[92:95], v14 offset:25600
    ds_read_b128 v[96:99], v14 offset:26624
    ds_read_b128 v[100:103], v14 offset:27648
    ds_read_b128 v[104:107], v14 offset:28672
    ds_read_b128 v[108:111], v14 offset:29696
    buffer_store_dwordx4 v[52:55], v11, s[20:23], s33 offen offset:3072 sc1
    ds_write_b128 v15, v[136:139] offset:24576
    buffer_store_dwordx4 v[56:59], v12, s[20:23], s34 offen offset:0 sc1 nt
    ds_write_b128 v15, v[140:143] offset:25600
    buffer_store_dwordx4 v[60:63], v13, s[20:23], s34 offen offset:1024 sc1 nt
    ds_write_b128 v15, v[144:147] offset:26624
    s_add_u32 s33, s28, 12582912
    s_add_u32 s34, s28, 12587008
    buffer_store_dwordx4 v[64:67], v8, s[20:23], s33 offen offset:0 sc1
    ds_write_b128 v15, v[148:151] offset:27648
    buffer_store_dwordx4 v[68:71], v9, s[20:23], s33 offen offset:1024 sc1 nt
    s_waitcnt vmcnt(33)
    ds_write_b128 v15, v[152:155] offset:28672
    buffer_store_dwordx4 v[72:75], v10, s[20:23], s33 offen offset:2048 sc1 nt
    s_waitcnt vmcnt(33)
    ds_write_b128 v15, v[156:159] offset:29696
    buffer_store_dwordx4 v[76:79], v11, s[20:23], s33 offen offset:3072 sc1
    s_waitcnt lgkmcnt(0)
    s_barrier
    buffer_store_dwordx4 v[80:83], v12, s[20:23], s34 offen offset:0 sc1 nt
    ds_read_b128 v[112:115], v14 offset:0
    ds_read_b128 v[116:119], v14 offset:1024
    ds_read_b128 v[120:123], v14 offset:2048
    ds_read_b128 v[124:127], v14 offset:3072
    ds_read_b128 v[128:131], v14 offset:4096
    ds_read_b128 v[132:135], v14 offset:5120
    buffer_store_dwordx4 v[84:87], v13, s[20:23], s34 offen offset:1024 sc1 nt
    s_waitcnt vmcnt(35)
    ds_write_b128 v15, v[160:163] offset:0
    s_add_u32 s33, s28, 18874368
    s_add_u32 s34, s28, 18878464
    buffer_store_dwordx4 v[88:91], v8, s[20:23], s33 offen offset:0 sc1
    s_waitcnt vmcnt(35)
    ds_write_b128 v15, v[164:167] offset:1024
    buffer_store_dwordx4 v[92:95], v9, s[20:23], s33 offen offset:1024 sc1 nt
    s_waitcnt vmcnt(35)
    ds_write_b128 v15, v[168:171] offset:2048
    buffer_store_dwordx4 v[96:99], v10, s[20:23], s33 offen offset:2048 sc1 nt
    s_waitcnt vmcnt(35)
    ds_write_b128 v15, v[172:175] offset:3072
    buffer_store_dwordx4 v[100:103], v11, s[20:23], s33 offen offset:3072 sc1
    s_waitcnt vmcnt(35)
    ds_write_b128 v15, v[176:179] offset:4096
    buffer_store_dwordx4 v[104:107], v12, s[20:23], s34 offen offset:0 sc1 nt
    s_waitcnt vmcnt(35)
    ds_write_b128 v15, v[180:183] offset:5120
    buffer_store_dwordx4 v[108:111], v13, s[20:23], s34 offen offset:1024 sc1 nt
    s_waitcnt lgkmcnt(0)
    s_barrier
    s_add_u32 s33, s28, 25165824
    s_add_u32 s34, s28, 25169920
    buffer_store_dwordx4 v[112:115], v8, s[20:23], s33 offen offset:0 sc1
    ds_read_b128 v[136:139], v14 offset:24576
    ds_read_b128 v[140:143], v14 offset:25600
    ds_read_b128 v[144:147], v14 offset:26624
    ds_read_b128 v[148:151], v14 offset:27648
    ds_read_b128 v[152:155], v14 offset:28672
    ds_read_b128 v[156:159], v14 offset:29696
    buffer_store_dwordx4 v[116:119], v9, s[20:23], s33 offen offset:1024 sc1 nt
    s_waitcnt vmcnt(37)
    ds_write_b128 v15, v[184:187] offset:24576
    buffer_store_dwordx4 v[120:123], v10, s[20:23], s33 offen offset:2048 sc1 nt
    s_waitcnt vmcnt(37)
    ds_write_b128 v15, v[188:191] offset:25600
    buffer_store_dwordx4 v[124:127], v11, s[20:23], s33 offen offset:3072 sc1
    s_waitcnt vmcnt(37)
    ds_write_b128 v15, v[192:195] offset:26624
    buffer_store_dwordx4 v[128:131], v12, s[20:23], s34 offen offset:0 sc1 nt
    s_waitcnt vmcnt(37)
    ds_write_b128 v15, v[196:199] offset:27648
    buffer_store_dwordx4 v[132:135], v13, s[20:23], s34 offen offset:1024 sc1 nt
    s_waitcnt vmcnt(37)
    ds_write_b128 v15, v[200:203] offset:28672
    s_add_u32 s33, s28, 31457280
    s_add_u32 s34, s28, 31461376
    s_waitcnt lgkmcnt(10)
    buffer_store_dwordx4 v[136:139], v8, s[20:23], s33 offen offset:0 sc1
    s_waitcnt vmcnt(37)
    ds_write_b128 v15, v[204:207] offset:29696
    s_waitcnt lgkmcnt(10)
    buffer_store_dwordx4 v[140:143], v9, s[20:23], s33 offen offset:1024 sc1 nt
    s_waitcnt lgkmcnt(9)
    buffer_store_dwordx4 v[144:147], v10, s[20:23], s33 offen offset:2048 sc1 nt
    s_waitcnt lgkmcnt(0)
    s_barrier
    buffer_store_dwordx4 v[148:151], v11, s[20:23], s33 offen offset:3072 sc1
    ds_read_b128 v[160:163], v14 offset:0
    ds_read_b128 v[164:167], v14 offset:1024
    ds_read_b128 v[168:171], v14 offset:2048
    ds_read_b128 v[172:175], v14 offset:3072
    ds_read_b128 v[176:179], v14 offset:4096
    ds_read_b128 v[180:183], v14 offset:5120
    buffer_store_dwordx4 v[152:155], v12, s[20:23], s34 offen offset:0 sc1 nt
    s_waitcnt vmcnt(40)
    ds_write_b128 v15, v[208:211] offset:0
    buffer_store_dwordx4 v[156:159], v13, s[20:23], s34 offen offset:1024 sc1 nt
    s_waitcnt vmcnt(40)
    ds_write_b128 v15, v[212:215] offset:1024
    s_add_u32 s33, s28, 37748736
    s_add_u32 s34, s28, 37752832
    s_waitcnt lgkmcnt(7)
    buffer_store_dwordx4 v[160:163], v8, s[20:23], s33 offen offset:0 sc1
    s_waitcnt vmcnt(40)
    ds_write_b128 v15, v[216:219] offset:2048
    s_waitcnt lgkmcnt(7)
    buffer_store_dwordx4 v[164:167], v9, s[20:23], s33 offen offset:1024 sc1 nt
    s_waitcnt vmcnt(40)
    ds_write_b128 v15, v[220:223] offset:3072
    s_waitcnt lgkmcnt(7)
    buffer_store_dwordx4 v[168:171], v10, s[20:23], s33 offen offset:2048 sc1 nt
    s_waitcnt vmcnt(40)
    ds_write_b128 v15, v[224:227] offset:4096
    s_waitcnt lgkmcnt(7)
    buffer_store_dwordx4 v[172:175], v11, s[20:23], s33 offen offset:3072 sc1
    s_waitcnt vmcnt(40)
    ds_write_b128 v15, v[228:231] offset:5120
    s_waitcnt lgkmcnt(7)
    buffer_store_dwordx4 v[176:179], v12, s[20:23], s34 offen offset:0 sc1 nt
    s_waitcnt lgkmcnt(6)
    buffer_store_dwordx4 v[180:183], v13, s[20:23], s34 offen offset:1024 sc1 nt
    s_waitcnt lgkmcnt(0)
    s_barrier
    ds_read_b128 v[184:187], v14 offset:24576
    ds_read_b128 v[188:191], v14 offset:25600
    ds_read_b128 v[192:195], v14 offset:26624
    ds_read_b128 v[196:199], v14 offset:27648
    ds_read_b128 v[200:203], v14 offset:28672
    ds_read_b128 v[204:207], v14 offset:29696
    s_add_u32 s33, s28, 44040192
    s_add_u32 s34, s28, 44044288
    s_waitcnt lgkmcnt(5)
    buffer_store_dwordx4 v[184:187], v8, s[20:23], s33 offen offset:0 sc1
    s_waitcnt lgkmcnt(4)
    buffer_store_dwordx4 v[188:191], v9, s[20:23], s33 offen offset:1024 sc1 nt
    s_waitcnt lgkmcnt(3)
    buffer_store_dwordx4 v[192:195], v10, s[20:23], s33 offen offset:2048 sc1 nt
    s_waitcnt lgkmcnt(2)
    buffer_store_dwordx4 v[196:199], v11, s[20:23], s33 offen offset:3072 sc1
    s_waitcnt lgkmcnt(1)
    buffer_store_dwordx4 v[200:203], v12, s[20:23], s34 offen offset:0 sc1 nt
    s_waitcnt lgkmcnt(0)
    buffer_store_dwordx4 v[204:207], v13, s[20:23], s34 offen offset:1024 sc1 nt
    s_waitcnt lgkmcnt(0)
    s_barrier
    ds_read_b128 v[208:211], v14 offset:0
    ds_read_b128 v[212:215], v14 offset:1024
    ds_read_b128 v[216:219], v14 offset:2048
    ds_read_b128 v[220:223], v14 offset:3072
    ds_read_b128 v[224:227], v14 offset:4096
    ds_read_b128 v[228:231], v14 offset:5120
    s_add_u32 s33, s28, 50331648
    s_add_u32 s34, s28, 50335744
    s_waitcnt lgkmcnt(5)
    buffer_store_dwordx4 v[208:211], v8, s[20:23], s33 offen offset:0 sc1
    s_waitcnt lgkmcnt(4)
    buffer_store_dwordx4 v[212:215], v9, s[20:23], s33 offen offset:1024 sc1 nt
    s_waitcnt lgkmcnt(3)
    buffer_store_dwordx4 v[216:219], v10, s[20:23], s33 offen offset:2048 sc1 nt
    s_waitcnt lgkmcnt(2)
    buffer_store_dwordx4 v[220:223], v11, s[20:23], s33 offen offset:3072 sc1
    s_waitcnt lgkmcnt(1)
    buffer_store_dwordx4 v[224:227], v12, s[20:23], s34 offen offset:0 sc1 nt
    s_waitcnt lgkmcnt(0)
    buffer_store_dwordx4 v[228:231], v13, s[20:23], s34 offen offset:1024 sc1 nt
    s_endpgm
L_cmain:
    s_barrier
    ds_read_b64 v[166:167], v10 offset:0
    ds_read_b64 v[170:171], v10 offset:32
    ds_read_b64 v[174:175], v10 offset:64
    ds_read_b64 v[178:179], v10 offset:96
    ds_read_b64 v[182:183], v10 offset:128
    ds_read_b64 v[186:187], v10 offset:160
    ds_read_b64_tr_b16 v[20:21], v252 offset:0
    ds_read_b64_tr_b16 v[22:23], v252 offset:1536
    ds_read_b128 v[188:191], v8 offset:0
    ds_read_b64_tr_b16 v[24:25], v252 offset:12288
    ds_read_b64_tr_b16 v[26:27], v252 offset:13824
    ds_read_b128 v[192:195], v9 offset:0
    ds_read_b64_tr_b16 v[28:29], v252 offset:24576
    ds_read_b64_tr_b16 v[30:31], v252 offset:26112
    ds_read_b128 v[196:199], v8 offset:128
    ds_read_b64_tr_b16 v[32:33], v252 offset:36864
    ds_read_b64_tr_b16 v[34:35], v252 offset:38400
    ds_read_b128 v[200:203], v9 offset:128
    ds_read_b64_tr_b16 v[36:37], v252 offset:49152
    ds_read_b64_tr_b16 v[38:39], v252 offset:50688
    ds_read_b128 v[204:207], v8 offset:256
    ds_read_b64_tr_b16 v[40:41], v252 offset:61440
    ds_read_b64_tr_b16 v[42:43], v252 offset:62976
    ds_read_b128 v[208:211], v9 offset:256
    ds_read_b64_tr_b16 v[44:45], v253 offset:0
    ds_read_b64_tr_b16 v[46:47], v253 offset:1536
    ds_read_b64_tr_b16 v[48:49], v253 offset:12288
    ds_read_b64_tr_b16 v[50:51], v253 offset:13824
    ds_read_b64_tr_b16 v[52:53], v253 offset:24576
    ds_read_b64_tr_b16 v[54:55], v253 offset:26112
    ds_read_b64_tr_b16 v[56:57], v253 offset:36864
    ds_read_b64_tr_b16 v[58:59], v253 offset:38400
    ds_read_b64_tr_b16 v[60:61], v253 offset:49152
    ds_read_b64_tr_b16 v[62:63], v253 offset:50688
    ds_read_b64_tr_b16 v[64:65], v253 offset:61440
    ds_read_b64_tr_b16 v[66:67], v253 offset:62976
    s_waitcnt lgkmcnt(14)
    v_lshlrev_b32 v164, 16, v166
    v_and_b32 v165, 0xffff0000, v166
    v_lshlrev_b32 v166, 16, v167
    v_and_b32 v167, 0xffff0000, v167
    v_lshlrev_b32 v168, 16, v170
    v_and_b32 v169, 0xffff0000, v170
    v_lshlrev_b32 v170, 16, v171
    v_and_b32 v171, 0xffff0000, v171
    v_lshlrev_b32 v172, 16, v174
    v_and_b32 v173, 0xffff0000, v174
    v_lshlrev_b32 v174, 16, v175
    v_and_b32 v175, 0xffff0000, v175
    v_lshlrev_b32 v176, 16, v178
    v_and_b32 v177, 0xffff0000, v178
    v_lshlrev_b32 v178, 16, v179
    v_and_b32 v179, 0xffff0000, v179
    v_lshlrev_b32 v180, 16, v182
    v_and_b32 v181, 0xffff0000, v182
    v_lshlrev_b32 v182, 16, v183
    v_and_b32 v183, 0xffff0000, v183
    v_lshlrev_b32 v184, 16, v186
    v_and_b32 v185, 0xffff0000, v186
    v_lshlrev_b32 v186, 16, v187
    v_and_b32 v187, 0xffff0000, v187
    s_waitcnt lgkmcnt(14)
    v_mfma_f32_16x16x32_bf16 v[236:239], v[20:23], v[188:191], v[164:167]
    ds_read_b64_tr_b16 v[68:69], v254 offset:0
    ds_read_b64_tr_b16 v[70:71], v254 offset:1536
    s_waitcnt lgkmcnt(14)
    v_mfma_f32_16x16x32_bf16 v[236:239], v[24:27], v[192:195], v[236:239]
    ds_read_b64_tr_b16 v[72:73], v254 offset:12288
    ds_read_b64_tr_b16 v[74:75], v254 offset:13824
    s_waitcnt lgkmcnt(14)
    v_mfma_f32_16x16x32_bf16 v[236:239], v[28:31], v[196:199], v[236:239]
    ds_read_b64_tr_b16 v[76:77], v254 offset:24576
    ds_read_b64_tr_b16 v[78:79], v254 offset:26112
    s_waitcnt lgkmcnt(14)
    v_mfma_f32_16x16x32_bf16 v[236:239], v[32:35], v[200:203], v[236:239]
    ds_read_b64_tr_b16 v[80:81], v254 offset:36864
    ds_read_b64_tr_b16 v[82:83], v254 offset:38400
    s_waitcnt lgkmcnt(14)
    v_mfma_f32_16x16x32_bf16 v[236:239], v[36:39], v[204:207], v[236:239]
    ds_read_b64_tr_b16 v[84:85], v254 offset:49152
    ds_read_b64_tr_b16 v[86:87], v254 offset:50688
    s_waitcnt lgkmcnt(14)
    v_mfma_f32_16x16x32_bf16 v[236:239], v[40:43], v[208:211], v[236:239]
    ds_read_b64_tr_b16 v[88:89], v254 offset:61440
    ds_read_b64_tr_b16 v[90:91], v254 offset:62976
    s_waitcnt lgkmcnt(14)
    v_mfma_f32_16x16x32_bf16 v[240:243], v[44:47], v[188:191], v[168:171]
    ds_read_b64_tr_b16 v[92:93], v255 offset:0
    ds_read_b64_tr_b16 v[94:95], v255 offset:1536
    s_waitcnt lgkmcnt(14)
    v_mfma_f32_16x16x32_bf16 v[240:243], v[48:51], v[192:195], v[240:243]
    ds_read_b64_tr_b16 v[96:97], v255 offset:12288
    ds_read_b64_tr_b16 v[98:99], v255 offset:13824
    s_waitcnt lgkmcnt(14)
    v_mfma_f32_16x16x32_bf16 v[240:243], v[52:55], v[196:199], v[240:243]
    ds_read_b64_tr_b16 v[100:101], v255 offset:24576
    ds_read_b64_tr_b16 v[102:103], v255 offset:26112
    s_waitcnt lgkmcnt(14)
    v_mfma_f32_16x16x32_bf16 v[240:243], v[56:59], v[200:203], v[240:243]
    ds_read_b64_tr_b16 v[104:105], v255 offset:36864
    ds_read_b64_tr_b16 v[106:107], v255 offset:38400
    s_waitcnt lgkmcnt(14)
    v_mfma_f32_16x16x32_bf16 v[240:243], v[60:63], v[204:207], v[240:243]
    ds_read_b64_tr_b16 v[108:109], v255 offset:49152
    ds_read_b64_tr_b16 v[110:111], v255 offset:50688
    s_waitcnt lgkmcnt(14)
    v_mfma_f32_16x16x32_bf16 v[240:243], v[64:67], v[208:211], v[240:243]
    ds_read_b64_tr_b16 v[112:113], v255 offset:61440
    ds_read_b64_tr_b16 v[114:115], v255 offset:62976
    s_waitcnt lgkmcnt(14)
    v_mfma_f32_16x16x32_bf16 v[244:247], v[68:71], v[188:191], v[172:175]
    ds_read_b64_tr_b16 v[116:117], v18 offset:0
    ds_read_b64_tr_b16 v[118:119], v18 offset:1536
    s_waitcnt lgkmcnt(14)
    v_mfma_f32_16x16x32_bf16 v[244:247], v[72:75], v[192:195], v[244:247]
    v_cvt_pk_bf16_f32 v236, v236, v237
    ds_read_b64_tr_b16 v[120:121], v18 offset:12288
    ds_read_b64_tr_b16 v[122:123], v18 offset:13824
    s_waitcnt lgkmcnt(14)
    v_mfma_f32_16x16x32_bf16 v[244:247], v[76:79], v[196:199], v[244:247]
    v_cvt_pk_bf16_f32 v237, v238, v239
    ds_read_b64_tr_b16 v[124:125], v18 offset:24576
    ds_read_b64_tr_b16 v[126:127], v18 offset:26112
    s_waitcnt lgkmcnt(14)
    v_mfma_f32_16x16x32_bf16 v[244:247], v[80:83], v[200:203], v[244:247]
    ds_write_b64 v12, v[236:237] offset:0
    ds_read_b64_tr_b16 v[128:129], v18 offset:36864
    ds_read_b64_tr_b16 v[130:131], v18 offset:38400
    s_waitcnt lgkmcnt(14)
    v_mfma_f32_16x16x32_bf16 v[244:247], v[84:87], v[204:207], v[244:247]
    ds_read_b64_tr_b16 v[132:133], v18 offset:49152
    ds_read_b64_tr_b16 v[134:135], v18 offset:50688
    s_waitcnt lgkmcnt(14)
    v_mfma_f32_16x16x32_bf16 v[244:247], v[88:91], v[208:211], v[244:247]
    ds_read_b64_tr_b16 v[136:137], v18 offset:61440
    ds_read_b64_tr_b16 v[138:139], v18 offset:62976
    s_waitcnt lgkmcnt(14)
    v_mfma_f32_16x16x32_bf16 v[248:251], v[92:95], v[188:191], v[176:179]
    ds_read_b64_tr_b16 v[140:141], v19 offset:0
    ds_read_b64_tr_b16 v[142:143], v19 offset:1536
    s_waitcnt lgkmcnt(14)
    v_mfma_f32_16x16x32_bf16 v[248:251], v[96:99], v[192:195], v[248:251]
    v_cvt_pk_bf16_f32 v240, v240, v241
    ds_read_b64_tr_b16 v[144:145], v19 offset:12288
    ds_read_b64_tr_b16 v[146:147], v19 offset:13824
    s_waitcnt lgkmcnt(14)
    v_mfma_f32_16x16x32_bf16 v[248:251], v[100:103], v[196:199], v[248:251]
    v_cvt_pk_bf16_f32 v241, v242, v243
    ds_read_b64_tr_b16 v[148:149], v19 offset:24576
    ds_read_b64_tr_b16 v[150:151], v19 offset:26112
    s_waitcnt lgkmcnt(14)
    v_mfma_f32_16x16x32_bf16 v[248:251], v[104:107], v[200:203], v[248:251]
    ds_write_b64 v13, v[240:241] offset:0
    ds_read_b64_tr_b16 v[152:153], v19 offset:36864
    ds_read_b64_tr_b16 v[154:155], v19 offset:38400
    s_waitcnt lgkmcnt(14)
    v_mfma_f32_16x16x32_bf16 v[248:251], v[108:111], v[204:207], v[248:251]
    ds_read_b64_tr_b16 v[156:157], v19 offset:49152
    ds_read_b64_tr_b16 v[158:159], v19 offset:50688
    s_waitcnt lgkmcnt(14)
    v_mfma_f32_16x16x32_bf16 v[248:251], v[112:115], v[208:211], v[248:251]
    ds_read_b64_tr_b16 v[160:161], v19 offset:61440
    ds_read_b64_tr_b16 v[162:163], v19 offset:62976
    s_waitcnt lgkmcnt(14)
    v_mfma_f32_16x16x32_bf16 v[236:239], v[116:119], v[188:191], v[180:183]
    ds_read_b128 v[212:215], v8 offset:6144
    ds_read_b128 v[216:219], v9 offset:6144
    s_waitcnt lgkmcnt(14)
    v_mfma_f32_16x16x32_bf16 v[236:239], v[120:123], v[192:195], v[236:239]
    v_cvt_pk_bf16_f32 v244, v244, v245
    ds_read_b128 v[220:223], v8 offset:6272
    ds_read_b128 v[224:227], v9 offset:6272
    s_waitcnt lgkmcnt(14)
    v_mfma_f32_16x16x32_bf16 v[236:239], v[124:127], v[196:199], v[236:239]
    v_cvt_pk_bf16_f32 v245, v246, v247
    ds_read_b128 v[228:231], v8 offset:6400
    ds_read_b128 v[232:235], v9 offset:6400
    s_waitcnt lgkmcnt(14)
    v_mfma_f32_16x16x32_bf16 v[236:239], v[128:131], v[200:203], v[236:239]
    ds_write_b64 v14, v[244:245] offset:0
    s_waitcnt lgkmcnt(14)
    v_mfma_f32_16x16x32_bf16 v[236:239], v[132:135], v[204:207], v[236:239]
    s_waitcnt lgkmcnt(14)
    v_mfma_f32_16x16x32_bf16 v[236:239], v[136:139], v[208:211], v[236:239]
    s_setprio 0
    s_waitcnt lgkmcnt(14)
    v_mfma_f32_16x16x32_bf16 v[240:243], v[140:143], v[188:191], v[184:187]
    s_waitcnt lgkmcnt(14)
    v_mfma_f32_16x16x32_bf16 v[240:243], v[144:147], v[192:195], v[240:243]
    v_cvt_pk_bf16_f32 v248, v248, v249
    s_waitcnt lgkmcnt(14)
    v_mfma_f32_16x16x32_bf16 v[240:243], v[148:151], v[196:199], v[240:243]
    v_cvt_pk_bf16_f32 v249, v250, v251
    s_waitcnt lgkmcnt(11)
    v_mfma_f32_16x16x32_bf16 v[240:243], v[152:155], v[200:203], v[240:243]
    ds_write_b64 v15, v[248:249] offset:0
    s_waitcnt lgkmcnt(10)
    v_mfma_f32_16x16x32_bf16 v[240:243], v[156:159], v[204:207], v[240:243]
    s_waitcnt lgkmcnt(8)
    v_mfma_f32_16x16x32_bf16 v[240:243], v[160:163], v[208:211], v[240:243]
    s_waitcnt lgkmcnt(7)
    v_mfma_f32_16x16x32_bf16 v[244:247], v[20:23], v[212:215], v[164:167]
    s_waitcnt lgkmcnt(6)
    v_mfma_f32_16x16x32_bf16 v[244:247], v[24:27], v[216:219], v[244:247]
    v_cvt_pk_bf16_f32 v236, v236, v237
    s_waitcnt lgkmcnt(5)
    v_mfma_f32_16x16x32_bf16 v[244:247], v[28:31], v[220:223], v[244:247]
    v_cvt_pk_bf16_f32 v237, v238, v239
    s_waitcnt lgkmcnt(4)
    v_mfma_f32_16x16x32_bf16 v[244:247], v[32:35], v[224:227], v[244:247]
    ds_write_b64 v16, v[236:237] offset:0
    s_waitcnt lgkmcnt(4)
    v_mfma_f32_16x16x32_bf16 v[244:247], v[36:39], v[228:231], v[244:247]
    s_waitcnt lgkmcnt(3)
    v_mfma_f32_16x16x32_bf16 v[244:247], v[40:43], v[232:235], v[244:247]
    v_mfma_f32_16x16x32_bf16 v[248:251], v[44:47], v[212:215], v[168:171]
    v_mfma_f32_16x16x32_bf16 v[248:251], v[48:51], v[216:219], v[248:251]
    v_cvt_pk_bf16_f32 v240, v240, v241
    v_mfma_f32_16x16x32_bf16 v[248:251], v[52:55], v[220:223], v[248:251]
    v_cvt_pk_bf16_f32 v241, v242, v243
    v_mfma_f32_16x16x32_bf16 v[248:251], v[56:59], v[224:227], v[248:251]
    ds_write_b64 v17, v[240:241] offset:0
    v_mfma_f32_16x16x32_bf16 v[248:251], v[60:63], v[228:231], v[248:251]
    v_mfma_f32_16x16x32_bf16 v[248:251], v[64:67], v[232:235], v[248:251]
    v_mfma_f32_16x16x32_bf16 v[236:239], v[68:71], v[212:215], v[172:175]
    v_mfma_f32_16x16x32_bf16 v[236:239], v[72:75], v[216:219], v[236:239]
    v_cvt_pk_bf16_f32 v244, v244, v245
    v_mfma_f32_16x16x32_bf16 v[236:239], v[76:79], v[220:223], v[236:239]
    v_cvt_pk_bf16_f32 v245, v246, v247
    v_mfma_f32_16x16x32_bf16 v[236:239], v[80:83], v[224:227], v[236:239]
    ds_write_b64 v12, v[244:245] offset:6144
    v_mfma_f32_16x16x32_bf16 v[236:239], v[84:87], v[228:231], v[236:239]
    v_mfma_f32_16x16x32_bf16 v[236:239], v[88:91], v[232:235], v[236:239]
    v_mfma_f32_16x16x32_bf16 v[240:243], v[92:95], v[212:215], v[176:179]
    v_mfma_f32_16x16x32_bf16 v[240:243], v[96:99], v[216:219], v[240:243]
    v_cvt_pk_bf16_f32 v248, v248, v249
    v_mfma_f32_16x16x32_bf16 v[240:243], v[100:103], v[220:223], v[240:243]
    v_cvt_pk_bf16_f32 v249, v250, v251
    v_mfma_f32_16x16x32_bf16 v[240:243], v[104:107], v[224:227], v[240:243]
    ds_write_b64 v13, v[248:249] offset:6144
    v_mfma_f32_16x16x32_bf16 v[240:243], v[108:111], v[228:231], v[240:243]
    v_mfma_f32_16x16x32_bf16 v[240:243], v[112:115], v[232:235], v[240:243]
    v_mfma_f32_16x16x32_bf16 v[244:247], v[116:119], v[212:215], v[180:183]
    v_mfma_f32_16x16x32_bf16 v[244:247], v[120:123], v[216:219], v[244:247]
    v_cvt_pk_bf16_f32 v236, v236, v237
    v_mfma_f32_16x16x32_bf16 v[244:247], v[124:127], v[220:223], v[244:247]
    v_cvt_pk_bf16_f32 v237, v238, v239
    v_mfma_f32_16x16x32_bf16 v[244:247], v[128:131], v[224:227], v[244:247]
    ds_write_b64 v14, v[236:237] offset:6144
    v_mfma_f32_16x16x32_bf16 v[244:247], v[132:135], v[228:231], v[244:247]
    v_mfma_f32_16x16x32_bf16 v[244:247], v[136:139], v[232:235], v[244:247]
    v_mfma_f32_16x16x32_bf16 v[248:251], v[140:143], v[212:215], v[184:187]
    v_mfma_f32_16x16x32_bf16 v[248:251], v[144:147], v[216:219], v[248:251]
    v_cvt_pk_bf16_f32 v240, v240, v241
    v_mfma_f32_16x16x32_bf16 v[248:251], v[148:151], v[220:223], v[248:251]
    v_cvt_pk_bf16_f32 v241, v242, v243
    v_mfma_f32_16x16x32_bf16 v[248:251], v[152:155], v[224:227], v[248:251]
    ds_write_b64 v15, v[240:241] offset:6144
    v_mfma_f32_16x16x32_bf16 v[248:251], v[156:159], v[228:231], v[248:251]
    v_mfma_f32_16x16x32_bf16 v[248:251], v[160:163], v[232:235], v[248:251]
    s_nop 1
    v_cvt_pk_bf16_f32 v244, v244, v245
    v_cvt_pk_bf16_f32 v245, v246, v247
    ds_write_b64 v16, v[244:245] offset:6144
    s_nop 2
    v_cvt_pk_bf16_f32 v248, v248, v249
    v_cvt_pk_bf16_f32 v249, v250, v251
    ds_write_b64 v17, v[248:249] offset:6144
    s_setprio 3
    s_waitcnt lgkmcnt(0)
L_loop:
    s_barrier
    ds_read_b128 v[188:191], v8 offset:24576
    ds_read_b128 v[192:195], v9 offset:24576
    ds_read_b128 v[196:199], v8 offset:24704
    ds_read_b128 v[200:203], v9 offset:24704
    ds_read_b128 v[204:207], v8 offset:24832
    ds_read_b128 v[208:211], v9 offset:24832
    ds_read_b128 v[212:215], v8 offset:30720
    ds_read_b128 v[216:219], v9 offset:30720
    ds_read_b128 v[220:223], v8 offset:30848
    ds_read_b128 v[224:227], v9 offset:30848
    ds_read_b128 v[228:231], v8 offset:30976
    ds_read_b128 v[232:235], v9 offset:30976
    s_setprio 0
    s_waitcnt lgkmcnt(11)
    v_mfma_f32_16x16x32_bf16 v[236:239], v[20:23], v[188:191], v[164:167]
    s_waitcnt lgkmcnt(10)
    v_mfma_f32_16x16x32_bf16 v[236:239], v[24:27], v[192:195], v[236:239]
    s_waitcnt lgkmcnt(9)
    v_mfma_f32_16x16x32_bf16 v[236:239], v[28:31], v[196:199], v[236:239]
    s_waitcnt lgkmcnt(8)
    v_mfma_f32_16x16x32_bf16 v[236:239], v[32:35], v[200:203], v[236:239]
    s_waitcnt lgkmcnt(7)
    v_mfma_f32_16x16x32_bf16 v[236:239], v[36:39], v[204:207], v[236:239]
    s_waitcnt lgkmcnt(6)
    v_mfma_f32_16x16x32_bf16 v[236:239], v[40:43], v[208:211], v[236:239]
    v_mfma_f32_16x16x32_bf16 v[240:243], v[44:47], v[188:191], v[168:171]
    v_mfma_f32_16x16x32_bf16 v[240:243], v[48:51], v[192:195], v[240:243]
    v_mfma_f32_16x16x32_bf16 v[240:243], v[52:55], v[196:199], v[240:243]
    v_mfma_f32_16x16x32_bf16 v[240:243], v[56:59], v[200:203], v[240:243]
    v_mfma_f32_16x16x32_bf16 v[240:243], v[60:63], v[204:207], v[240:243]
    v_mfma_f32_16x16x32_bf16 v[240:243], v[64:67], v[208:211], v[240:243]
    v_mfma_f32_16x16x32_bf16 v[244:247], v[68:71], v[188:191], v[172:175]
    v_mfma_f32_16x16x32_bf16 v[244:247], v[72:75], v[192:195], v[244:247]
    v_cvt_pk_bf16_f32 v236, v236, v237
    v_mfma_f32_16x16x32_bf16 v[244:247], v[76:79], v[196:199], v[244:247]
    v_cvt_pk_bf16_f32 v237, v238, v239
    v_mfma_f32_16x16x32_bf16 v[244:247], v[80:83], v[200:203], v[244:247]
    ds_write_b64 v12, v[236:237] offset:24576
    v_mfma_f32_16x16x32_bf16 v[244:247], v[84:87], v[204:207], v[244:247]
    v_mfma_f32_16x16x32_bf16 v[244:247], v[88:91], v[208:211], v[244:247]
    v_mfma_f32_16x16x32_bf16 v[248:251], v[92:95], v[188:191], v[176:179]
    v_mfma_f32_16x16x32_bf16 v[248:251], v[96:99], v[192:195], v[248:251]
    v_cvt_pk_bf16_f32 v240, v240, v241
    v_mfma_f32_16x16x32_bf16 v[248:251], v[100:103], v[196:199], v[248:251]
    v_cvt_pk_bf16_f32 v241, v242, v243
    v_mfma_f32_16x16x32_bf16 v[248:251], v[104:107], v[200:203], v[248:251]
    ds_write_b64 v13, v[240:241] offset:24576
    v_mfma_f32_16x16x32_bf16 v[248:251], v[108:111], v[204:207], v[248:251]
    v_mfma_f32_16x16x32_bf16 v[248:251], v[112:115], v[208:211], v[248:251]
    v_mfma_f32_16x16x32_bf16 v[236:239], v[116:119], v[188:191], v[180:183]
    v_mfma_f32_16x16x32_bf16 v[236:239], v[120:123], v[192:195], v[236:239]
    v_cvt_pk_bf16_f32 v244, v244, v245
    v_mfma_f32_16x16x32_bf16 v[236:239], v[124:127], v[196:199], v[236:239]
    v_cvt_pk_bf16_f32 v245, v246, v247
    v_mfma_f32_16x16x32_bf16 v[236:239], v[128:131], v[200:203], v[236:239]
    ds_write_b64 v14, v[244:245] offset:24576
    v_mfma_f32_16x16x32_bf16 v[236:239], v[132:135], v[204:207], v[236:239]
    v_mfma_f32_16x16x32_bf16 v[236:239], v[136:139], v[208:211], v[236:239]
    v_mfma_f32_16x16x32_bf16 v[240:243], v[140:143], v[188:191], v[184:187]
    v_mfma_f32_16x16x32_bf16 v[240:243], v[144:147], v[192:195], v[240:243]
    v_cvt_pk_bf16_f32 v248, v248, v249
    v_mfma_f32_16x16x32_bf16 v[240:243], v[148:151], v[196:199], v[240:243]
    v_cvt_pk_bf16_f32 v249, v250, v251
    v_mfma_f32_16x16x32_bf16 v[240:243], v[152:155], v[200:203], v[240:243]
    ds_write_b64 v15, v[248:249] offset:24576
    v_mfma_f32_16x16x32_bf16 v[240:243], v[156:159], v[204:207], v[240:243]
    v_mfma_f32_16x16x32_bf16 v[240:243], v[160:163], v[208:211], v[240:243]
    s_waitcnt lgkmcnt(9)
    v_mfma_f32_16x16x32_bf16 v[244:247], v[20:23], v[212:215], v[164:167]
    s_waitcnt lgkmcnt(8)
    v_mfma_f32_16x16x32_bf16 v[244:247], v[24:27], v[216:219], v[244:247]
    v_cvt_pk_bf16_f32 v236, v236, v237
    s_waitcnt lgkmcnt(7)
    v_mfma_f32_16x16x32_bf16 v[244:247], v[28:31], v[220:223], v[244:247]
    v_cvt_pk_bf16_f32 v237, v238, v239
    s_waitcnt lgkmcnt(6)
    v_mfma_f32_16x16x32_bf16 v[244:247], v[32:35], v[224:227], v[244:247]
    ds_write_b64 v16, v[236:237] offset:24576
    s_waitcnt lgkmcnt(6)
    v_mfma_f32_16x16x32_bf16 v[244:247], v[36:39], v[228:231], v[244:247]
    s_waitcnt lgkmcnt(5)
    v_mfma_f32_16x16x32_bf16 v[244:247], v[40:43], v[232:235], v[244:247]
    v_mfma_f32_16x16x32_bf16 v[248:251], v[44:47], v[212:215], v[168:171]
    v_mfma_f32_16x16x32_bf16 v[248:251], v[48:51], v[216:219], v[248:251]
    v_cvt_pk_bf16_f32 v240, v240, v241
    v_mfma_f32_16x16x32_bf16 v[248:251], v[52:55], v[220:223], v[248:251]
    v_cvt_pk_bf16_f32 v241, v242, v243
    v_mfma_f32_16x16x32_bf16 v[248:251], v[56:59], v[224:227], v[248:251]
    ds_write_b64 v17, v[240:241] offset:24576
    v_mfma_f32_16x16x32_bf16 v[248:251], v[60:63], v[228:231], v[248:251]
    v_mfma_f32_16x16x32_bf16 v[248:251], v[64:67], v[232:235], v[248:251]
    v_mfma_f32_16x16x32_bf16 v[236:239], v[68:71], v[212:215], v[172:175]
    v_mfma_f32_16x16x32_bf16 v[236:239], v[72:75], v[216:219], v[236:239]
    v_cvt_pk_bf16_f32 v244, v244, v245
    v_mfma_f32_16x16x32_bf16 v[236:239], v[76:79], v[220:223], v[236:239]
    v_cvt_pk_bf16_f32 v245, v246, v247
    v_mfma_f32_16x16x32_bf16 v[236:239], v[80:83], v[224:227], v[236:239]
    ds_write_b64 v12, v[244:245] offset:30720
    v_mfma_f32_16x16x32_bf16 v[236:239], v[84:87], v[228:231], v[236:239]
    v_mfma_f32_16x16x32_bf16 v[236:239], v[88:91], v[232:235], v[236:239]
    v_mfma_f32_16x16x32_bf16 v[240:243], v[92:95], v[212:215], v[176:179]
    v_mfma_f32_16x16x32_bf16 v[240:243], v[96:99], v[216:219], v[240:243]
    v_cvt_pk_bf16_f32 v248, v248, v249
    v_mfma_f32_16x16x32_bf16 v[240:243], v[100:103], v[220:223], v[240:243]
    v_cvt_pk_bf16_f32 v249, v250, v251
    v_mfma_f32_16x16x32_bf16 v[240:243], v[104:107], v[224:227], v[240:243]
    ds_write_b64 v13, v[248:249] offset:30720
    v_mfma_f32_16x16x32_bf16 v[240:243], v[108:111], v[228:231], v[240:243]
    v_mfma_f32_16x16x32_bf16 v[240:243], v[112:115], v[232:235], v[240:243]
    v_mfma_f32_16x16x32_bf16 v[244:247], v[116:119], v[212:215], v[180:183]
    v_mfma_f32_16x16x32_bf16 v[244:247], v[120:123], v[216:219], v[244:247]
    v_cvt_pk_bf16_f32 v236, v236, v237
    v_mfma_f32_16x16x32_bf16 v[244:247], v[124:127], v[220:223], v[244:247]
    v_cvt_pk_bf16_f32 v237, v238, v239
    v_mfma_f32_16x16x32_bf16 v[244:247], v[128:131], v[224:227], v[244:247]
    ds_write_b64 v14, v[236:237] offset:30720
    v_mfma_f32_16x16x32_bf16 v[244:247], v[132:135], v[228:231], v[244:247]
    v_mfma_f32_16x16x32_bf16 v[244:247], v[136:139], v[232:235], v[244:247]
    v_mfma_f32_16x16x32_bf16 v[248:251], v[140:143], v[212:215], v[184:187]
    v_mfma_f32_16x16x32_bf16 v[248:251], v[144:147], v[216:219], v[248:251]
    v_cvt_pk_bf16_f32 v240, v240, v241
    v_mfma_f32_16x16x32_bf16 v[248:251], v[148:151], v[220:223], v[248:251]
    v_cvt_pk_bf16_f32 v241, v242, v243
    v_mfma_f32_16x16x32_bf16 v[248:251], v[152:155], v[224:227], v[248:251]
    ds_write_b64 v15, v[240:241] offset:30720
    v_mfma_f32_16x16x32_bf16 v[248:251], v[156:159], v[228:231], v[248:251]
    v_mfma_f32_16x16x32_bf16 v[248:251], v[160:163], v[232:235], v[248:251]
    s_nop 1
    v_cvt_pk_bf16_f32 v244, v244, v245
    v_cvt_pk_bf16_f32 v245, v246, v247
    ds_write_b64 v16, v[244:245] offset:30720
    s_nop 2
    v_cvt_pk_bf16_f32 v248, v248, v249
    v_cvt_pk_bf16_f32 v249, v250, v251
    ds_write_b64 v17, v[248:249] offset:30720
    s_setprio 3
    s_waitcnt lgkmcnt(0)
    s_barrier
    ds_read_b128 v[188:191], v8 offset:0
    ds_read_b128 v[192:195], v9 offset:0
    ds_read_b128 v[196:199], v8 offset:128
    ds_read_b128 v[200:203], v9 offset:128
    ds_read_b128 v[204:207], v8 offset:256
    ds_read_b128 v[208:211], v9 offset:256
    ds_read_b128 v[212:215], v8 offset:6144
    ds_read_b128 v[216:219], v9 offset:6144
    ds_read_b128 v[220:223], v8 offset:6272
    ds_read_b128 v[224:227], v9 offset:6272
    ds_read_b128 v[228:231], v8 offset:6400
    ds_read_b128 v[232:235], v9 offset:6400
    s_setprio 0
    s_waitcnt lgkmcnt(11)
    v_mfma_f32_16x16x32_bf16 v[236:239], v[20:23], v[188:191], v[164:167]
    s_waitcnt lgkmcnt(10)
    v_mfma_f32_16x16x32_bf16 v[236:239], v[24:27], v[192:195], v[236:239]
    s_waitcnt lgkmcnt(9)
    v_mfma_f32_16x16x32_bf16 v[236:239], v[28:31], v[196:199], v[236:239]
    s_waitcnt lgkmcnt(8)
    v_mfma_f32_16x16x32_bf16 v[236:239], v[32:35], v[200:203], v[236:239]
    s_waitcnt lgkmcnt(7)
    v_mfma_f32_16x16x32_bf16 v[236:239], v[36:39], v[204:207], v[236:239]
    s_waitcnt lgkmcnt(6)
    v_mfma_f32_16x16x32_bf16 v[236:239], v[40:43], v[208:211], v[236:239]
    v_mfma_f32_16x16x32_bf16 v[240:243], v[44:47], v[188:191], v[168:171]
    v_mfma_f32_16x16x32_bf16 v[240:243], v[48:51], v[192:195], v[240:243]
    v_mfma_f32_16x16x32_bf16 v[240:243], v[52:55], v[196:199], v[240:243]
    v_mfma_f32_16x16x32_bf16 v[240:243], v[56:59], v[200:203], v[240:243]
    v_mfma_f32_16x16x32_bf16 v[240:243], v[60:63], v[204:207], v[240:243]
    v_mfma_f32_16x16x32_bf16 v[240:243], v[64:67], v[208:211], v[240:243]
    v_mfma_f32_16x16x32_bf16 v[244:247], v[68:71], v[188:191], v[172:175]
    v_mfma_f32_16x16x32_bf16 v[244:247], v[72:75], v[192:195], v[244:247]
    v_cvt_pk_bf16_f32 v236, v236, v237
    v_mfma_f32_16x16x32_bf16 v[244:247], v[76:79], v[196:199], v[244:247]
    v_cvt_pk_bf16_f32 v237, v238, v239
    v_mfma_f32_16x16x32_bf16 v[244:247], v[80:83], v[200:203], v[244:247]
    ds_write_b64 v12, v[236:237] offset:0
    v_mfma_f32_16x16x32_bf16 v[244:247], v[84:87], v[204:207], v[244:247]
    v_mfma_f32_16x16x32_bf16 v[244:247], v[88:91], v[208:211], v[244:247]
    v_mfma_f32_16x16x32_bf16 v[248:251], v[92:95], v[188:191], v[176:179]
    v_mfma_f32_16x16x32_bf16 v[248:251], v[96:99], v[192:195], v[248:251]
    v_cvt_pk_bf16_f32 v240, v240, v241
    v_mfma_f32_16x16x32_bf16 v[248:251], v[100:103], v[196:199], v[248:251]
    v_cvt_pk_bf16_f32 v241, v242, v243
    v_mfma_f32_16x16x32_bf16 v[248:251], v[104:107], v[200:203], v[248:251]
    ds_write_b64 v13, v[240:241] offset:0
    v_mfma_f32_16x16x32_bf16 v[248:251], v[108:111], v[204:207], v[248:251]
    v_mfma_f32_16x16x32_bf16 v[248:251], v[112:115], v[208:211], v[248:251]
    v_mfma_f32_16x16x32_bf16 v[236:239], v[116:119], v[188:191], v[180:183]
    v_mfma_f32_16x16x32_bf16 v[236:239], v[120:123], v[192:195], v[236:239]
    v_cvt_pk_bf16_f32 v244, v244, v245
    v_mfma_f32_16x16x32_bf16 v[236:239], v[124:127], v[196:199], v[236:239]
    v_cvt_pk_bf16_f32 v245, v246, v247
    v_mfma_f32_16x16x32_bf16 v[236:239], v[128:131], v[200:203], v[236:239]
    ds_write_b64 v14, v[244:245] offset:0
    v_mfma_f32_16x16x32_bf16 v[236:239], v[132:135], v[204:207], v[236:239]
    v_mfma_f32_16x16x32_bf16 v[236:239], v[136:139], v[208:211], v[236:239]
    v_mfma_f32_16x16x32_bf16 v[240:243], v[140:143], v[188:191], v[184:187]
    v_mfma_f32_16x16x32_bf16 v[240:243], v[144:147], v[192:195], v[240:243]
    v_cvt_pk_bf16_f32 v248, v248, v249
    v_mfma_f32_16x16x32_bf16 v[240:243], v[148:151], v[196:199], v[240:243]
    v_cvt_pk_bf16_f32 v249, v250, v251
    v_mfma_f32_16x16x32_bf16 v[240:243], v[152:155], v[200:203], v[240:243]
    ds_write_b64 v15, v[248:249] offset:0
    v_mfma_f32_16x16x32_bf16 v[240:243], v[156:159], v[204:207], v[240:243]
    v_mfma_f32_16x16x32_bf16 v[240:243], v[160:163], v[208:211], v[240:243]
    s_waitcnt lgkmcnt(9)
    v_mfma_f32_16x16x32_bf16 v[244:247], v[20:23], v[212:215], v[164:167]
    s_waitcnt lgkmcnt(8)
    v_mfma_f32_16x16x32_bf16 v[244:247], v[24:27], v[216:219], v[244:247]
    v_cvt_pk_bf16_f32 v236, v236, v237
    s_waitcnt lgkmcnt(7)
    v_mfma_f32_16x16x32_bf16 v[244:247], v[28:31], v[220:223], v[244:247]
    v_cvt_pk_bf16_f32 v237, v238, v239
    s_waitcnt lgkmcnt(6)
    v_mfma_f32_16x16x32_bf16 v[244:247], v[32:35], v[224:227], v[244:247]
    ds_write_b64 v16, v[236:237] offset:0
    s_waitcnt lgkmcnt(6)
    v_mfma_f32_16x16x32_bf16 v[244:247], v[36:39], v[228:231], v[244:247]
    s_waitcnt lgkmcnt(5)
    v_mfma_f32_16x16x32_bf16 v[244:247], v[40:43], v[232:235], v[244:247]
    v_mfma_f32_16x16x32_bf16 v[248:251], v[44:47], v[212:215], v[168:171]
    v_mfma_f32_16x16x32_bf16 v[248:251], v[48:51], v[216:219], v[248:251]
    v_cvt_pk_bf16_f32 v240, v240, v241
    v_mfma_f32_16x16x32_bf16 v[248:251], v[52:55], v[220:223], v[248:251]
    v_cvt_pk_bf16_f32 v241, v242, v243
    v_mfma_f32_16x16x32_bf16 v[248:251], v[56:59], v[224:227], v[248:251]
    ds_write_b64 v17, v[240:241] offset:0
    v_mfma_f32_16x16x32_bf16 v[248:251], v[60:63], v[228:231], v[248:251]
    v_mfma_f32_16x16x32_bf16 v[248:251], v[64:67], v[232:235], v[248:251]
    v_mfma_f32_16x16x32_bf16 v[236:239], v[68:71], v[212:215], v[172:175]
    v_mfma_f32_16x16x32_bf16 v[236:239], v[72:75], v[216:219], v[236:239]
    v_cvt_pk_bf16_f32 v244, v244, v245
    v_mfma_f32_16x16x32_bf16 v[236:239], v[76:79], v[220:223], v[236:239]
    v_cvt_pk_bf16_f32 v245, v246, v247
    v_mfma_f32_16x16x32_bf16 v[236:239], v[80:83], v[224:227], v[236:239]
    ds_write_b64 v12, v[244:245] offset:6144
    v_mfma_f32_16x16x32_bf16 v[236:239], v[84:87], v[228:231], v[236:239]
    v_mfma_f32_16x16x32_bf16 v[236:239], v[88:91], v[232:235], v[236:239]
    v_mfma_f32_16x16x32_bf16 v[240:243], v[92:95], v[212:215], v[176:179]
    v_mfma_f32_16x16x32_bf16 v[240:243], v[96:99], v[216:219], v[240:243]
    v_cvt_pk_bf16_f32 v248, v248, v249
    v_mfma_f32_16x16x32_bf16 v[240:243], v[100:103], v[220:223], v[240:243]
    v_cvt_pk_bf16_f32 v249, v250, v251
    v_mfma_f32_16x16x32_bf16 v[240:243], v[104:107], v[224:227], v[240:243]
    ds_write_b64 v13, v[248:249] offset:6144
    v_mfma_f32_16x16x32_bf16 v[240:243], v[108:111], v[228:231], v[240:243]
    v_mfma_f32_16x16x32_bf16 v[240:243], v[112:115], v[232:235], v[240:243]
    v_mfma_f32_16x16x32_bf16 v[244:247], v[116:119], v[212:215], v[180:183]
    v_mfma_f32_16x16x32_bf16 v[244:247], v[120:123], v[216:219], v[244:247]
    v_cvt_pk_bf16_f32 v236, v236, v237
    v_mfma_f32_16x16x32_bf16 v[244:247], v[124:127], v[220:223], v[244:247]
    v_cvt_pk_bf16_f32 v237, v238, v239
    v_mfma_f32_16x16x32_bf16 v[244:247], v[128:131], v[224:227], v[244:247]
    ds_write_b64 v14, v[236:237] offset:6144
    v_mfma_f32_16x16x32_bf16 v[244:247], v[132:135], v[228:231], v[244:247]
    v_mfma_f32_16x16x32_bf16 v[244:247], v[136:139], v[232:235], v[244:247]
    v_mfma_f32_16x16x32_bf16 v[248:251], v[140:143], v[212:215], v[184:187]
    v_mfma_f32_16x16x32_bf16 v[248:251], v[144:147], v[216:219], v[248:251]
    v_cvt_pk_bf16_f32 v240, v240, v241
    v_mfma_f32_16x16x32_bf16 v[248:251], v[148:151], v[220:223], v[248:251]
    v_cvt_pk_bf16_f32 v241, v242, v243
    v_mfma_f32_16x16x32_bf16 v[248:251], v[152:155], v[224:227], v[248:251]
    ds_write_b64 v15, v[240:241] offset:6144
    v_mfma_f32_16x16x32_bf16 v[248:251], v[156:159], v[228:231], v[248:251]
    v_mfma_f32_16x16x32_bf16 v[248:251], v[160:163], v[232:235], v[248:251]
    s_nop 1
    v_cvt_pk_bf16_f32 v244, v244, v245
    v_cvt_pk_bf16_f32 v245, v246, v247
    ds_write_b64 v16, v[244:245] offset:6144
    s_nop 2
    v_cvt_pk_bf16_f32 v248, v248, v249
    v_cvt_pk_bf16_f32 v249, v250, v251
    ds_write_b64 v17, v[248:249] offset:6144
    s_setprio 3
    s_waitcnt lgkmcnt(0)
    s_add_u32 s34, s34, 2
    s_cmp_lt_u32 s34, 8
    s_cbranch_scc1 L_loop
L_cdone:
    s_barrier
L_fin:
L_end:
    s_endpgm
.section .rodata,"a"
.p2align 6
.amdhsa_kernel standalone__standard_2d_1d_3d_conv__vision_kernel
  .amdhsa_next_free_vgpr 256
  .amdhsa_next_free_sgpr 96
  .amdhsa_accum_offset 256
  .amdhsa_group_segment_fixed_size 0
  .amdhsa_kernarg_size 48
  .amdhsa_user_sgpr_count 2
  .amdhsa_user_sgpr_kernarg_segment_ptr 1
  .amdhsa_system_sgpr_workgroup_id_x 1
.end_amdhsa_kernel
```
